```python
import torch

def _softmax(x, axis=-1):
    return torch.softmax(x, dim=axis)
def _gelu(x):
    return torch.nn.functional.gelu(x, approximate="tanh")
def _silu(x):
    return torch.nn.functional.silu(x)
def _sigmoid(x):
    return torch.sigmoid(x)
def _layernorm(x, axis=-1, eps=1e-5):
    m = x.mean(dim=axis, keepdim=True)
    v = x.var(dim=axis, keepdim=True, unbiased=False)
    return (x - m) / torch.sqrt(v + eps)
def _scatter_add(tgt, idx, src, axis=0):
    return tgt.clone().index_add_(axis, idx, src)
def _segment_sum(src, seg, n):
    out = torch.zeros((n,) + src.shape[1:], dtype=src.dtype)
    return out.index_add_(0, seg, src)
def _pad(x, pw):
    flat = tuple(v for pair in reversed(pw) for v in pair)
    return torch.nn.functional.pad(x, flat)

kernel_name = 'gather_scatter__mpnn_edge_mlp__graph'

def setup_inputs():

    _w = (lambda a: (lambda t: t.to(torch.bfloat16) if t.is_floating_point() else t)(torch.as_tensor(a)))
    N, deg, D, De = 10000, 16, 256, max(0, 1)
    E = N * deg
    return {
        "x": _w((lambda *s: torch.randn(*s, dtype=torch.bfloat16) * 0.05)(N, D)),
        "e_attr": _w((lambda *s: torch.randn(*s, dtype=torch.bfloat16) * 0.4)(E, De)),
        "src": _w((lambda lo, hi, *s: torch.randint(lo, hi, s))(0, N, E).to(torch.int64)),
        "dst": _w((lambda lo, hi, *s: torch.randint(lo, hi, s))(0, N, E).to(torch.int64)),
        "w_msg": _w((lambda *s: torch.randn(*s, dtype=torch.bfloat16) * 0.4)(2 * D + De, D)),
        "w_upd": _w((lambda *s: torch.randn(*s, dtype=torch.bfloat16) * 0.05)(2 * D, D)),
    }

def reference(x, e_attr, src, dst, w_msg, w_upd):
    N, D = x.shape
    m_in = torch.concatenate([x[src], x[dst], e_attr], axis=-1)
    msg = _silu(m_in @ w_msg)
    agg = _segment_sum(msg, dst, N)
    return _silu(torch.concatenate([x, agg], axis=-1) @ w_upd)
```

```asm
; @launch grid=(250,1,1) block=(1024,1,1) lds=163840
.amdgcn_target "amdgcn-amd-amdhsa--gfx950"
.text
.globl gather_scatter__mpnn_edge_mlp__graph_kernel
.p2align 8
.type gather_scatter__mpnn_edge_mlp__graph_kernel,@function
gather_scatter__mpnn_edge_mlp__graph_kernel:
    s_cmp_ge_u32 s2, 250
    s_cbranch_scc1 L_end
    s_load_dwordx16 s[40:55], s[0:1], 0
    s_load_dwordx2 s[56:57], s[0:1], 64
    v_and_b32 v1, 63, v0
    s_getpc_b64 s[4:5]
L_pc:
    v_lshlrev_b32 v58, 4, v0
    v_min_u32 v58, L_end-L_pc-12, v58
    global_load_dwordx4 v[112:115], v58, s[4:5]
    v_lshrrev_b32 v58, 6, v0
    v_mov_b32 v64, 0
    v_lshlrev_b32 v65, 2, v0
    v_readfirstlane_b32 s3, v58
    v_add_u32 v65, 151552, v65
    s_cmp_lt_u32 s3, 4
    s_cbranch_scc1 L_z1
    s_cmp_gt_u32 s3, 5
    s_cbranch_scc1 L_z2
    v_add_u32 v65, 8192, v65
L_z1:
    ds_write_b32 v65, v64
L_z2:
    v_lshrrev_b32 v61, 5, v0
    v_and_b32 v62, 31, v0
    v_and_b32 v63, 15, v61
    v_xor_b32 v64, v63, v62
    v_lshlrev_b32 v64, 4, v64
    s_mul_i32 s89, s2, 20480
    v_lshl_add_u32 v64, v61, 9, v64
    v_add_u32 v7, s89, v64
    v_and_b32 v64, 3, v63
    v_lshrrev_b32 v65, 1, v63
    v_and_b32 v65, 4, v65
    v_or_b32 v64, v64, v65
    v_lshlrev_b32 v64, 1, v64
    v_xor_b32 v64, v64, v62
    v_lshlrev_b32 v64, 4, v64
    v_lshl_add_u32 v120, v63, 9, v64
    s_and_b32 s63, s3, 7
    s_lshl_b32 s63, s63, 10
    s_mov_b32 s34, 640000
    s_mov_b32 s35, 0x20000
    s_mov_b32 s30, 640000
    s_mov_b32 s31, 0x20000
    s_mov_b32 s38, 320000
    s_mov_b32 s39, 0x20000
    s_mov_b32 s10, 262656
    s_mov_b32 s11, 0x20000
    s_mov_b32 s14, 262144
    s_mov_b32 s15, 0x20000
    s_mov_b32 s18, 10485760
    s_mov_b32 s19, 0x20000
    s_mov_b32 s6, 5120000
    s_mov_b32 s7, 0x20000
    s_waitcnt lgkmcnt(0)
    s_mov_b64 s[32:33], s[46:47]
    s_mov_b64 s[28:29], s[44:45]
    s_mov_b64 s[36:37], s[42:43]
    s_mov_b64 s[4:5], s[40:41]
    s_mov_b64 s[8:9], s[48:49]
    s_mov_b64 s[12:13], s[50:51]
    s_mov_b64 s[16:17], s[56:57]
    v_mov_b32 v58, 0
    s_cmp_ge_u32 s3, 8
    s_cbranch_scc1 L_role_l
    s_cmp_ge_u32 s3, 5
    s_cbranch_scc1 L_role_u
    s_setprio 3
    v_lshlrev_b32 v64, 3, v0
    v_lshlrev_b32 v65, 2, v0
    s_mul_i32 s88, s2, 2560
    s_mul_i32 s89, s2, 1280
    buffer_load_dwordx2 v[24:25], v64, s[32:35], s88 offen
    buffer_load_dwordx2 v[26:27], v64, s[28:31], s88 offen
    buffer_load_dword v28, v65, s[36:39], s89 offen
    buffer_load_dwordx2 v[124:125], v58, s[16:19], 0 offen
    s_sub_u32 s88, s3, 1
    s_and_b32 s88, s88, 7
    s_mul_i32 s91, s88, 250
    s_add_u32 s91, s91, s2
    s_lshl_b32 s88, s88, 10
    s_add_u32 m0, s88, 98304
    s_and_b32 s88, s91, 7
    s_bfe_u32 s89, s91, 0x40003
    s_lshr_b32 s90, s91, 7
    s_lshl_b32 s64, s89, 4
    s_lshl_b32 s65, s90, 3
    s_add_u32 s64, s64, s65
    s_add_u32 s64, s64, s88
    s_lshl_b32 s65, s64, 5
    s_add_u32 s65, s65, 4096
    s_lshl_b32 s64, s64, 10
    s_add_u32 s64, s64, 7340032
    s_lshl_b32 s88, s88, 5
    s_lshl_b32 s89, s89, 5
    s_cmp_lt_u32 s91, 256
    s_cselect_b32 s89, s89, 2147483648
    s_cselect_b32 s64, s64, 2147483648
    s_cselect_b32 s65, s65, 2147483648
    v_lshrrev_b32 v64, 1, v1
    v_add_u32 v64, s88, v64
    v_and_b32 v63, 1, v1
    v_lshlrev_b32 v63, 4, v63
    s_cmp_eq_u32 s90, 0
    s_cbranch_scc1 L_pc_u1
    v_and_b32 v65, 3, v64
    v_lshrrev_b32 v64, 2, v64
    v_lshl_add_u32 v64, v65, 6, v64
    v_add_u32 v64, 256, v64
L_pc_u1:
    v_lshl_add_u32 v64, v64, 9, v63
    buffer_load_dwordx4 v64, s[12:15], s89 offen lds
    s_branch L_role_done
L_role_u:
    buffer_load_dwordx2 v[124:125], v58, s[16:19], 0 offen
    v_subrev_u32 v61, 10, v61
    s_mul_i32 s89, s2, 20480
    s_lshl_b32 s88, s3, 10
    v_and_b32 v64, 15, v61
    v_xor_b32 v64, v64, v62
    v_lshlrev_b32 v64, 4, v64
    s_add_u32 m0, s88, 125952
    v_lshl_add_u32 v64, v61, 9, v64
    v_add_u32 v61, 6, v61
    buffer_load_dwordx4 v64, s[4:7], s89 offen lds
    v_and_b32 v64, 15, v61
    v_xor_b32 v64, v64, v62
    v_lshlrev_b32 v64, 4, v64
    s_add_u32 m0, s88, 129024
    v_lshl_add_u32 v64, v61, 9, v64
    v_add_u32 v61, 6, v61
    buffer_load_dwordx4 v64, s[4:7], s89 offen lds
    v_and_b32 v64, 15, v61
    v_xor_b32 v64, v64, v62
    v_lshlrev_b32 v64, 4, v64
    s_add_u32 m0, s88, 132096
    v_lshl_add_u32 v64, v61, 9, v64
    v_add_u32 v61, 6, v61
    buffer_load_dwordx4 v64, s[4:7], s89 offen lds
    v_and_b32 v64, 15, v61
    v_xor_b32 v64, v64, v62
    v_lshlrev_b32 v64, 4, v64
    s_add_u32 m0, s88, 135168
    v_lshl_add_u32 v64, v61, 9, v64
    v_add_u32 v61, 6, v61
    buffer_load_dwordx4 v64, s[4:7], s89 offen lds
    v_and_b32 v64, 15, v61
    v_xor_b32 v64, v64, v62
    v_lshlrev_b32 v64, 4, v64
    s_add_u32 m0, s88, 138240
    v_lshl_add_u32 v64, v61, 9, v64
    v_add_u32 v61, 6, v61
    buffer_load_dwordx4 v64, s[4:7], s89 offen lds
    v_and_b32 v64, 15, v61
    v_xor_b32 v64, v64, v62
    v_lshlrev_b32 v64, 4, v64
    s_add_u32 m0, s88, 141312
    v_lshl_add_u32 v64, v61, 9, v64
    v_add_u32 v61, 6, v61
    buffer_load_dwordx4 v64, s[4:7], s89 offen lds
    s_cmp_eq_u32 s3, 7
    s_cselect_b32 s90, 2, 0
    v_subrev_u32 v61, s90, v61
    s_lshl_b32 s90, s90, 9
    s_sub_u32 s88, s88, s90
    v_and_b32 v64, 15, v61
    v_xor_b32 v64, v64, v62
    v_lshlrev_b32 v64, 4, v64
    s_add_u32 m0, s88, 144384
    v_lshl_add_u32 v64, v61, 9, v64
    v_add_u32 v61, 6, v61
    buffer_load_dwordx4 v64, s[4:7], s89 offen lds
    s_branch L_role_done
L_role_l:
    buffer_load_dwordx2 v[124:125], v58, s[16:19], 0 offen
    s_lshr_b32 s88, s2, 3
    s_lshl_b32 s88, s88, 13
    s_add_u32 s88, s88, s63
    s_lshr_b32 s90, s88, 1
    v_lshlrev_b32 v65, 3, v1
    buffer_load_dwordx2 v[104:105], v65, s[8:11], s90 offen
    s_add_u32 s90, s90, 131072
    buffer_load_dwordx2 v[106:107], v65, s[8:11], s90 offen
    s_cmp_eq_u32 s3, 15
    s_cbranch_scc0 L_role_done
    s_mov_b32 m0, 161088
    v_lshlrev_b32 v65, 4, v1
    s_mov_b32 s89, 262144
    buffer_load_dwordx4 v65, s[8:11], s89 offen lds
L_role_done:
    s_barrier
    s_mov_b32 s24, s52
    s_mov_b32 s25, s53
    s_mov_b32 s26, 5120000
    s_mov_b32 s27, 0x20000
    s_add_u32 s20, s56, 2097152
    s_addc_u32 s21, s57, 0
    s_or_b32 s21, s21, 33554432
    s_mov_b32 s22, 10000
    s_mov_b32 s23, 0x20000
    s_mov_b32 s58, 3216550459
    s_mov_b32 s59, 3216550459
    s_mov_b32 s60, 3207688728
    s_mov_b32 s61, 3207688728
    s_lshl_b32 s62, s3, 10
    s_lshr_b32 s49, s3, 3
    s_lshl_b32 s49, s49, 13
    s_mov_b32 s57, 0
    v_and_b32 v58, 15, v1
    v_lshrrev_b32 v59, 4, v1
    v_bfe_u32 v60, v1, 2, 2
    v_and_b32 v61, 3, v1
    s_lshl_b32 s89, s3, 1
    v_and_b32 v62, 1, v59
    v_lshl_or_b32 v62, v62, 2, v60
    v_lshlrev_b32 v62, 1, v62
    v_lshrrev_b32 v63, 1, v61
    v_add_u32 v63, s89, v63
    v_xor_b32 v62, v62, v63
    v_lshlrev_b32 v62, 4, v62
    v_and_b32 v63, 1, v61
    v_lshl_add_u32 v62, v63, 3, v62
    v_lshl_add_u32 v63, v59, 3, v60
    v_lshl_add_u32 v121, v63, 9, v62
    v_add_u32 v122, 65536, v121
    v_lshlrev_b32 v63, 5, v63
    v_lshl_add_u32 v119, v61, 3, v63
    v_lshlrev_b32 v63, 9, v58
    v_add_u32 v63, 131072, v63
    v_add_u32 v62, 0, v59
    v_xor_b32 v62, v62, v58
    v_lshl_add_u32 v2, v62, 4, v63
    v_add_u32 v62, 4, v59
    v_xor_b32 v62, v62, v58
    v_lshl_add_u32 v3, v62, 4, v63
    v_add_u32 v62, 8, v59
    v_xor_b32 v62, v62, v58
    v_lshl_add_u32 v4, v62, 4, v63
    v_add_u32 v62, 12, v59
    v_xor_b32 v62, v62, v58
    v_lshl_add_u32 v5, v62, 4, v63
    v_lshrrev_b32 v62, 1, v59
    v_add_u32 v62, s89, v62
    v_xor_b32 v62, v62, v58
    v_lshlrev_b32 v62, 4, v62
    v_and_b32 v64, 1, v59
    v_lshl_add_u32 v62, v64, 3, v62
    v_lshl_add_u32 v62, v58, 9, v62
    v_add_u32 v6, 65536, v62
    v_lshlrev_b32 v9, 4, v0
    v_add_u32 v9, 65536, v9
    v_add_u32 v8, 16384, v7
    s_cmp_lt_u32 s3, 4
    s_cbranch_scc1 L_go2
    v_mov_b32 v8, 2147483648
L_go2:
    s_cmp_lt_u32 s3, 5
    s_cbranch_scc0 L_nobin
    s_mov_b32 s90, -40
    s_mov_b32 s91, 151552
    v_mov_b32 v52, 1
    v_mov_b32 v56, 161036
    v_lshlrev_b32 v53, 4, v1
    v_add_u32 v54, 151552, v53
    s_waitcnt vmcnt(1)
    v_readfirstlane_b32 s52, v124
    v_readfirstlane_b32 s53, v125
    s_add_u32 s52, s52, 1
    s_addc_u32 s53, s53, 0
    s_lshl_b32 s56, s53, 20
    s_lshl_b32 s29, s52, 24
    s_bfe_u32 s31, s52, 0x100008
    v_mul_u32_u24 v30, 52429, v24
    v_mul_u32_u24 v31, 52429, v25
    v_lshrrev_b32 v30, 21, v30
    v_lshrrev_b32 v31, 21, v31
    v_min_u32 v32, 255, v30
    v_min_u32 v33, 255, v31
    v_and_b32 v30, 7, v32
    v_lshrrev_b32 v40, 3, v32
    v_and_b32 v31, 7, v33
    v_lshrrev_b32 v41, 3, v33
    v_lshl_or_b32 v30, v30, 5, v40
    v_lshl_or_b32 v31, v31, 5, v41
    v_lshl_add_u32 v30, v30, 2, s91
    v_lshl_add_u32 v31, v31, 2, s91
    v_mad_i32_i24 v24, v32, s90, v24
    ds_add_rtn_u32 v32, v30, v52
    v_mad_i32_i24 v25, v33, s90, v25
    ds_add_rtn_u32 v33, v31, v52
    s_mov_b64 exec, 1
    ds_add_u32 v56, v52
    s_mov_b64 exec, -1
    v_and_b32 v24, 63, v24
    v_and_b32 v26, 0xffff, v26
    v_and_b32 v25, 63, v25
    v_and_b32 v27, 0xffff, v27
    v_lshl_or_b32 v34, v24, 16, v26
    v_lshl_or_b32 v36, v25, 16, v27
    v_mov_b32 v37, 0xffff0000
    v_lshl_or_b32 v35, v28, 16, s31
    v_and_or_b32 v37, v28, v37, s31
    v_or_b32 v34, s29, v34
    v_or_b32 v36, s29, v36
    v_mov_b32 v56, 161036
L_spin_1:
    ds_read_b32 v57, v56
    ds_read_b128 v[40:43], v54
    s_waitcnt lgkmcnt(0)
    v_readfirstlane_b32 s88, v57
    s_nop 0
    s_cmp_lt_u32 s88, 5
    s_cbranch_scc1 L_spin_1
    v_add_u32 v45, v40, v41
    v_add_u32 v48, v42, v43
    v_add_u32 v48, v48, v45
    v_mov_b32 v49, v48
    s_nop 1
    v_add_u32_dpp v49, v49, v49 row_shr:1 row_mask:0xf bank_mask:0xf bound_ctrl:0
    s_nop 1
    v_add_u32_dpp v49, v49, v49 row_shr:2 row_mask:0xf bank_mask:0xf bound_ctrl:0
    s_nop 1
    v_add_u32_dpp v49, v49, v49 row_shr:4 row_mask:0xf bank_mask:0xf bound_ctrl:0
    s_nop 1
    v_add_u32_dpp v49, v49, v49 row_shr:8 row_mask:0xf bank_mask:0xf bound_ctrl:0
    s_nop 1
    v_add_u32_dpp v49, v49, v49 row_bcast:15 row_mask:0xa bank_mask:0xf
    s_nop 1
    v_add_u32_dpp v49, v49, v49 row_bcast:31 row_mask:0xc bank_mask:0xf
    v_sub_u32 v44, v49, v48
    v_add_u32 v46, v44, v45
    v_add_u32 v45, v44, v40
    v_add_u32 v47, v46, v42
    ds_write_b128 v54, v[44:47] offset:1024
    ds_read_b32 v24, v30 offset:1024
    ds_read_b32 v25, v31 offset:1024
    s_mov_b32 s91, 153600
    v_mov_b32 v56, 161040
    v_lshlrev_b32 v53, 4, v0
    v_add_u32 v54, 153600, v53
    s_mul_i32 s89, s2, 5120
    s_add_u32 s89, s89, 589824
    s_waitcnt lgkmcnt(0)
    v_add_u32 v24, v24, v32
    v_add_u32 v25, v25, v33
    v_lshl_add_u32 v24, v24, 3, s91
    v_lshl_add_u32 v25, v25, 3, s91
    ds_write_b64 v24, v[34:35]
    ds_write_b64 v25, v[36:37]
    s_mov_b64 exec, 1
    ds_add_u32 v56, v52
    s_mov_b64 exec, -1
    v_mov_b32 v56, 161040
L_spin_2:
    ds_read_b32 v57, v56
    ds_read_b128 v[48:51], v54
    s_waitcnt lgkmcnt(0)
    v_readfirstlane_b32 s88, v57
    s_nop 0
    s_cmp_lt_u32 s88, 5
    s_cbranch_scc1 L_spin_2
    buffer_store_dwordx4 v[48:51], v53, s[16:19], s89 offen sc1
    s_cmp_eq_u32 s3, 0
    s_cbranch_scc0 L_piece
    v_lshlrev_b32 v58, 3, v1
    v_add_u32 v58, 151552, v58
    ds_read_b64 v[66:67], v58
    ds_read_b64 v[68:69], v58 offset:1024
    ds_read_b64 v[70:71], v58 offset:512
    ds_read_b64 v[72:73], v58 offset:1536
    v_lshlrev_b32 v59, 4, v1
    s_lshl_b32 s89, s2, 11
    s_add_u32 s89, s89, 65536
    s_waitcnt lgkmcnt(0)
    v_lshl_or_b32 v12, v66, 10, v68
    v_mov_b32 v13, s52
    v_or_b32 v12, s56, v12
    v_lshl_or_b32 v14, v67, 10, v69
    v_mov_b32 v15, s52
    v_or_b32 v14, s56, v14
    v_lshl_or_b32 v16, v70, 10, v72
    v_mov_b32 v17, s52
    v_or_b32 v16, s56, v16
    v_lshl_or_b32 v18, v71, 10, v73
    v_mov_b32 v19, s52
    v_or_b32 v18, s56, v18
    buffer_store_dwordx4 v[12:15], v59, s[16:19], s89 offen sc1
    buffer_store_dwordx4 v[16:19], v59, s[16:19], s89 offen offset:1024 sc1
    s_setprio 0
    s_branch L_bin_done
L_piece:
    s_setprio 0
    s_cmp_lt_u32 s3, 3
    s_cbranch_scc0 L_bin_done
    s_lshl_b32 s88, s3, 10
    s_add_u32 s88, s88, 97280
    v_add_u32 v119, s88, v119
    v_lshlrev_b32 v126, 4, v1
    s_waitcnt vmcnt(1)
    ds_read_b64_tr_b16 v[108:109], v119
    ds_read_b64_tr_b16 v[110:111], v119 offset:128
    s_waitcnt lgkmcnt(0)
    buffer_store_dwordx4 v[108:111], v126, s[16:19], s64 offen sc1
    s_branch L_bin_done
L_nobin:
    s_cmp_ge_u32 s3, 8
    s_cbranch_scc1 L_bin_ld
    v_mov_b32 v126, 161032
    v_mov_b32 v127, 1
    s_mov_b64 exec, 1
    s_waitcnt vmcnt(4)
    ds_add_u32 v126, v127
    s_mov_b64 exec, -1
    s_branch L_bin_done
L_bin_ld:
    s_add_u32 m0, s63, 0
    s_mov_b32 s89, 0
    buffer_load_dwordx4 v120, s[8:11], s89 offen lds
    s_add_u32 m0, s63, 8192
    s_mov_b32 s89, 8192
    buffer_load_dwordx4 v120, s[8:11], s89 offen lds
    s_add_u32 m0, s63, 16384
    s_mov_b32 s89, 16384
    buffer_load_dwordx4 v120, s[8:11], s89 offen lds
    s_add_u32 m0, s63, 24576
    s_mov_b32 s89, 24576
    buffer_load_dwordx4 v120, s[8:11], s89 offen lds
    s_waitcnt vmcnt(6)
L_bin_done:
    v_readfirstlane_b32 s52, v124
    v_readfirstlane_b32 s53, v125
    s_add_u32 s52, s52, 1
    s_addc_u32 s53, s53, 0
    s_lshl_b32 s56, s53, 20
    s_lshl_b32 s29, s52, 24
    s_bfe_u32 s31, s52, 0x100008
    v_mov_b32 v96, 161032
L_xs_3:
    ds_read_b32 v97, v96
    s_waitcnt lgkmcnt(0)
    v_readfirstlane_b32 s88, v97
    s_nop 0
    s_bfe_u32 s88, s88, 262144
    s_cmp_lt_u32 s88, 3
    s_cbranch_scc0 L_xs_3_ok
    s_sleep 1
    s_branch L_xs_3
L_xs_3_ok:
    ds_read_b128 v[24:27], v2 offset:0
    ds_read_b128 v[28:31], v3 offset:0
    ds_read_b128 v[32:35], v4 offset:0
    ds_read_b128 v[36:39], v5 offset:0
    ds_read_b128 v[40:43], v2 offset:256
    ds_read_b128 v[44:47], v3 offset:256
    ds_read_b128 v[48:51], v4 offset:256
    ds_read_b128 v[52:55], v5 offset:256
    s_cmp_lt_u32 s3, 5
    s_cbranch_scc1 L_xp_go
    s_cmp_ge_u32 s3, 8
    s_cbranch_scc1 L_xp_go
    v_mov_b32 v127, 16
    s_mov_b64 exec, 1
    s_waitcnt vmcnt(0)
    ds_add_u32 v96, v127
    s_mov_b64 exec, -1
L_xp_go:
L_xs_4:
    ds_read_b32 v97, v96
    s_waitcnt lgkmcnt(0)
    v_readfirstlane_b32 s88, v97
    s_nop 0
    s_bfe_u32 s88, s88, 262148
    s_cmp_lt_u32 s88, 3
    s_cbranch_scc0 L_xs_4_ok
    s_sleep 1
    s_branch L_xs_4
L_xs_4_ok:
    ds_read_b128 v[56:59], v2 offset:8192
    ds_read_b128 v[60:63], v3 offset:8192
    ds_read_b128 v[64:67], v4 offset:8192
    ds_read_b128 v[68:71], v5 offset:8192
    ds_read_b128 v[72:75], v2 offset:8448
    ds_read_b128 v[76:79], v3 offset:8448
    ds_read_b128 v[80:83], v4 offset:8448
    ds_read_b128 v[84:87], v5 offset:8448
    ds_read_b128 v[88:91], v2 offset:16384
    ds_read_b128 v[92:95], v3 offset:16384
    s_cmp_lt_u32 s3, 8
    s_cbranch_scc1 L_xp_c2
    s_add_u32 m0, s63, 32768
    s_mov_b32 s89, 32768
    buffer_load_dwordx4 v120, s[8:11], s89 offen lds
    s_add_u32 m0, s63, 40960
    s_mov_b32 s89, 40960
    buffer_load_dwordx4 v120, s[8:11], s89 offen lds
    s_add_u32 m0, s63, 49152
    s_mov_b32 s89, 49152
    buffer_load_dwordx4 v120, s[8:11], s89 offen lds
    s_add_u32 m0, s63, 57344
    s_mov_b32 s89, 57344
    buffer_load_dwordx4 v120, s[8:11], s89 offen lds
    s_branch L_xp_done
L_xp_c2:
    s_add_u32 m0, s63, 65536
    s_mov_b32 s89, 65536
    buffer_load_dwordx4 v120, s[8:11], s89 offen lds
    s_add_u32 m0, s63, 73728
    s_mov_b32 s89, 73728
    buffer_load_dwordx4 v120, s[8:11], s89 offen lds
    s_add_u32 m0, s63, 81920
    s_mov_b32 s89, 81920
    buffer_load_dwordx4 v120, s[8:11], s89 offen lds
    s_add_u32 m0, s63, 90112
    s_mov_b32 s89, 90112
    buffer_load_dwordx4 v120, s[8:11], s89 offen lds
L_xp_done:
    s_cmp_lt_u32 s3, 8
    s_cbranch_scc1 L_vw_5
    s_waitcnt vmcnt(4)
L_vw_5:
    s_barrier
    s_sub_u32 s88, s3, 1
    s_cmp_lt_u32 s88, 2
    s_cbranch_scc0 L_notag
    s_waitcnt vmcnt(4)
    v_mov_b32 v116, s52
    v_mov_b32 v117, s53
    v_lshlrev_b32 v118, 24, v1
    buffer_store_dwordx2 v[116:117], v118, s[16:19], s65 offen sc1
L_notag:
    ds_read_b64_tr_b16 v[96:97], v121 offset:0
    ds_read_b64_tr_b16 v[98:99], v121 offset:2048
    ds_read_b64_tr_b16 v[100:101], v121 offset:16384
    ds_read_b64_tr_b16 v[102:103], v121 offset:18432
    s_add_u32 m0, s62, 98304
    s_add_u32 s89, s49, 98304
    buffer_load_dwordx4 v120, s[8:11], s89 offen lds
    s_waitcnt lgkmcnt(2)
    v_mfma_f32_16x16x32_bf16 v[104:107], v[96:99], v[24:27], 0
    v_mfma_f32_16x16x32_bf16 v[108:111], v[96:99], v[56:59], 0
    v_mfma_f32_16x16x32_bf16 v[112:115], v[96:99], v[88:91], 0
    s_add_u32 m0, s62, 114688
    s_add_u32 s89, s49, 114688
    buffer_load_dwordx4 v120, s[8:11], s89 offen lds
    s_waitcnt lgkmcnt(0)
    v_mfma_f32_16x16x32_bf16 v[104:107], v[100:103], v[28:31], v[104:107]
    v_mfma_f32_16x16x32_bf16 v[108:111], v[100:103], v[60:63], v[108:111]
    v_mfma_f32_16x16x32_bf16 v[112:115], v[100:103], v[92:95], v[112:115]
    ds_read_b128 v[88:91], v4 offset:16384
    ds_read_b128 v[92:95], v5 offset:16384
    s_cmp_lt_u32 s3, 8
    s_cbranch_scc1 L_vw_6
    s_waitcnt vmcnt(2)
L_vw_6:
    s_barrier
    ds_read_b64_tr_b16 v[96:97], v121 offset:32768
    ds_read_b64_tr_b16 v[98:99], v121 offset:34816
    ds_read_b64_tr_b16 v[100:101], v121 offset:49152
    ds_read_b64_tr_b16 v[102:103], v121 offset:51200
    s_add_u32 m0, s62, 0
    s_add_u32 s89, s49, 131072
    buffer_load_dwordx4 v120, s[8:11], s89 offen lds
    s_waitcnt lgkmcnt(2)
    v_mfma_f32_16x16x32_bf16 v[104:107], v[96:99], v[32:35], v[104:107]
    v_mfma_f32_16x16x32_bf16 v[108:111], v[96:99], v[64:67], v[108:111]
    v_mfma_f32_16x16x32_bf16 v[112:115], v[96:99], v[88:91], v[112:115]
    s_add_u32 m0, s62, 16384
    s_add_u32 s89, s49, 147456
    buffer_load_dwordx4 v120, s[8:11], s89 offen lds
    s_waitcnt lgkmcnt(0)
    v_mfma_f32_16x16x32_bf16 v[104:107], v[100:103], v[36:39], v[104:107]
    v_mfma_f32_16x16x32_bf16 v[108:111], v[100:103], v[68:71], v[108:111]
    v_mfma_f32_16x16x32_bf16 v[112:115], v[100:103], v[92:95], v[112:115]
    ds_read_b128 v[88:91], v2 offset:16640
    ds_read_b128 v[92:95], v3 offset:16640
    s_cmp_ge_u32 s3, 8
    s_cbranch_scc1 L_vw_7
    s_waitcnt vmcnt(4)
L_vw_7:
    s_barrier
    ds_read_b64_tr_b16 v[96:97], v122 offset:0
    ds_read_b64_tr_b16 v[98:99], v122 offset:2048
    ds_read_b64_tr_b16 v[100:101], v122 offset:16384
    ds_read_b64_tr_b16 v[102:103], v122 offset:18432
    s_add_u32 m0, s62, 32768
    s_add_u32 s89, s49, 163840
    buffer_load_dwordx4 v120, s[8:11], s89 offen lds
    s_waitcnt lgkmcnt(2)
    v_mfma_f32_16x16x32_bf16 v[104:107], v[96:99], v[40:43], v[104:107]
    v_mfma_f32_16x16x32_bf16 v[108:111], v[96:99], v[72:75], v[108:111]
    v_mfma_f32_16x16x32_bf16 v[112:115], v[96:99], v[88:91], v[112:115]
    s_add_u32 m0, s62, 49152
    s_add_u32 s89, s49, 180224
    buffer_load_dwordx4 v120, s[8:11], s89 offen lds
    s_waitcnt lgkmcnt(0)
    v_mfma_f32_16x16x32_bf16 v[104:107], v[100:103], v[44:47], v[104:107]
    v_mfma_f32_16x16x32_bf16 v[108:111], v[100:103], v[76:79], v[108:111]
    v_mfma_f32_16x16x32_bf16 v[112:115], v[100:103], v[92:95], v[112:115]
    ds_read_b128 v[88:91], v4 offset:16640
    ds_read_b128 v[92:95], v5 offset:16640
    s_waitcnt vmcnt(4)
    s_barrier
    ds_read_b64_tr_b16 v[96:97], v122 offset:32768
    ds_read_b64_tr_b16 v[98:99], v122 offset:34816
    ds_read_b64_tr_b16 v[100:101], v122 offset:49152
    ds_read_b64_tr_b16 v[102:103], v122 offset:51200
    s_waitcnt lgkmcnt(2)
    v_mfma_f32_16x16x32_bf16 v[104:107], v[96:99], v[48:51], v[104:107]
    v_mfma_f32_16x16x32_bf16 v[108:111], v[96:99], v[80:83], v[108:111]
    v_mfma_f32_16x16x32_bf16 v[112:115], v[96:99], v[88:91], v[112:115]
    s_waitcnt lgkmcnt(0)
    v_mfma_f32_16x16x32_bf16 v[104:107], v[100:103], v[52:55], v[104:107]
    v_mfma_f32_16x16x32_bf16 v[108:111], v[100:103], v[84:87], v[108:111]
    v_mfma_f32_16x16x32_bf16 v[112:115], v[100:103], v[92:95], v[112:115]
    v_mov_b32 v23, 2147483648
    v_lshrrev_b32 v10, 2, v0
    v_lshlrev_b32 v22, 11, v10
    s_movk_i32 s88, 250
    v_cmp_gt_u32 s[80:81], s88, v10
    s_mov_b32 s75, 0
    s_mov_b32 s76, 4
    s_mov_b32 s79, 0
    v_cndmask_b32 v22, v23, v22, s[80:81]
    s_and_b32 s90, s2, 7
    s_lshl_b32 s90, s90, 8
    s_and_b32 s89, s2, 0xf8
    s_add_u32 s90, s90, s89
    s_add_u32 s90, s90, 65536
    buffer_load_dwordx2 v[20:21], v22, s[16:19], s90 offen sc1
    v_pk_mul_f32 v[104:105], v[104:105], s[58:59] op_sel_hi:[1,0]
    v_pk_mul_f32 v[106:107], v[106:107], s[58:59] op_sel_hi:[1,0]
    v_cvt_pk_bf16_f32 v104, v104, v105
    v_cvt_pk_bf16_f32 v105, v106, v107
    ds_write_b64 v6, v[104:105] offset:0
    v_pk_mul_f32 v[108:109], v[108:109], s[58:59] op_sel_hi:[1,0]
    v_pk_mul_f32 v[110:111], v[110:111], s[58:59] op_sel_hi:[1,0]
    v_cvt_pk_bf16_f32 v108, v108, v109
    v_cvt_pk_bf16_f32 v109, v110, v111
    ds_write_b64 v6, v[108:109] offset:8192
    v_pk_mul_f32 v[112:113], v[112:113], s[58:59] op_sel_hi:[1,0]
    v_pk_mul_f32 v[114:115], v[114:115], s[58:59] op_sel_hi:[1,0]
    v_cvt_pk_bf16_f32 v112, v112, v113
    v_cvt_pk_bf16_f32 v113, v114, v115
    ds_write_b64 v6, v[112:113] offset:16384
    s_setprio 3
    s_waitcnt lgkmcnt(0)
    s_barrier
    ds_read_b128 v[104:107], v9
    ds_read_b128 v[108:111], v9 offset:16384
    ds_read_b128 v[88:91], v2 offset:16384
    ds_read_b128 v[92:95], v3 offset:16384
    s_mov_b32 s89, 2097152
    s_waitcnt lgkmcnt(3)
    buffer_store_dwordx4 v[104:107], v7, s[16:19], s89 offen sc1
    s_waitcnt lgkmcnt(2)
    buffer_store_dwordx4 v[108:111], v8, s[16:19], s89 offen sc1
    s_setprio 0
    s_waitcnt vmcnt(2)
    v_xor_b32 v23, s56, v20
    v_cmp_ne_u32 vcc, s52, v21
    s_mov_b32 s89, 0x100000
    v_cmp_le_u32 s[40:41], s89, v23
    s_nop 1
    s_or_b64 vcc, vcc, s[40:41]
    s_and_b64 vcc, vcc, s[80:81]
    s_mov_b32 s39, 0
    s_cbranch_scc1 L_late
    v_cndmask_b32 v20, 0, v23, s[80:81]
    v_and_b32 v23, 3, v0
    v_mul_u32_u24 v22, 5120, v10
    v_and_b32 v16, 0x3ff, v20
    v_bfe_u32 v17, v20, 10, 10
    v_add_u32 v16, v16, v23
    v_lshl_add_u32 v22, v16, 3, v22
    v_add_u32 v10, 589824, v22
    v_sub_u32 v11, v17, v23
    v_cmp_lt_u32 vcc, 16, v17
    s_cbranch_vccz L_nomax_8
    v_mov_b32 v16, 161024
    s_mov_b64 exec, vcc
    ds_max_u32 v16, v17
    s_mov_b64 exec, -1
    s_waitcnt lgkmcnt(0)
L_nomax_8:
    s_lshl_b32 s88, s75, 2
    s_lshl_b32 s89, s75, 5
    v_mov_b32 v18, 2147483648
    s_add_u32 s90, s88, 4
    s_add_u32 s91, s88, 8
    v_cmp_lt_i32 s[80:81], s88, v11
    s_add_u32 s88, s88, 12
    v_cmp_lt_i32 s[82:83], s90, v11
    v_cmp_lt_i32 s[84:85], s91, v11
    v_cmp_lt_i32 s[86:87], s88, v11
    s_cmp_gt_u32 s76, 1
    s_cselect_b64 s[82:83], s[82:83], 0
    s_cselect_b64 s[84:85], s[84:85], 0
    s_cselect_b64 s[86:87], s[86:87], 0
    s_cmp_eq_u64 s[84:85], 0
    s_cbranch_scc1 L_hp_9
    v_cndmask_b32 v14, v18, v10, s[84:85]
    buffer_load_dwordx2 v[124:125], v14, s[16:19], s89 offen offset:64 sc1
    v_cndmask_b32 v15, v18, v10, s[86:87]
    buffer_load_dwordx2 v[126:127], v15, s[16:19], s89 offen offset:96 sc1
L_hp_9:
    v_cndmask_b32 v12, v18, v10, s[80:81]
    buffer_load_dwordx2 v[116:117], v12, s[16:19], s89 offen offset:0 sc1
    v_cndmask_b32 v13, v18, v10, s[82:83]
    buffer_load_dwordx2 v[118:119], v13, s[16:19], s89 offen offset:32 sc1
    s_mov_b32 s39, 1
    s_branch L_intime
L_late:
    s_and_b32 s90, s2, 7
    s_lshl_b32 s90, s90, 8
    s_and_b32 s89, s2, 0xf8
    s_add_u32 s90, s90, s89
    s_add_u32 s90, s90, 65536
    buffer_load_dwordx2 v[20:21], v22, s[16:19], s90 offen sc1
    s_and_b32 s90, s2, 7
    s_lshl_b32 s90, s90, 8
    s_and_b32 s89, s2, 0xf8
    s_add_u32 s90, s90, s89
    s_add_u32 s90, s90, 65536
    buffer_load_dwordx2 v[20:21], v22, s[16:19], s90 offen sc1
L_intime:
    s_barrier
    ds_read_b64_tr_b16 v[96:97], v121 offset:0
    ds_read_b64_tr_b16 v[98:99], v121 offset:2048
    ds_read_b64_tr_b16 v[100:101], v121 offset:16384
    ds_read_b64_tr_b16 v[102:103], v121 offset:18432
    s_waitcnt lgkmcnt(2)
    v_mfma_f32_16x16x32_bf16 v[104:107], v[96:99], v[24:27], 0
    v_mfma_f32_16x16x32_bf16 v[108:111], v[96:99], v[56:59], 0
    v_mfma_f32_16x16x32_bf16 v[112:115], v[96:99], v[88:91], 0
    s_waitcnt lgkmcnt(0)
    v_mfma_f32_16x16x32_bf16 v[104:107], v[100:103], v[28:31], v[104:107]
    v_mfma_f32_16x16x32_bf16 v[108:111], v[100:103], v[60:63], v[108:111]
    v_mfma_f32_16x16x32_bf16 v[112:115], v[100:103], v[92:95], v[112:115]
    ds_read_b128 v[88:91], v4 offset:16384
    ds_read_b128 v[92:95], v5 offset:16384
    v_lshlrev_b32 v26, 5, v1
    s_lshl_b32 s90, s3, 9
    s_add_u32 s90, s90, 4096
    s_mov_b64 exec, 0xffff
    buffer_load_dwordx2 v[24:25], v26, s[16:19], s90 offen sc1
    s_mov_b64 exec, -1
    s_waitcnt vmcnt(3)
    s_barrier
    s_cmp_eq_u32 s3, 0
    s_cbranch_scc0 L_w0_10
    s_lshl_b32 s89, s2, 5
    s_add_u32 s89, s89, 12288
    v_mov_b32 v12, s52
    v_mov_b32 v13, s53
    v_lshlrev_b32 v14, 24, v1
    buffer_store_dwordx2 v[12:13], v14, s[16:19], s89 offen sc1
L_w0_10:
    ds_read_b64_tr_b16 v[96:97], v121 offset:32768
    ds_read_b64_tr_b16 v[98:99], v121 offset:34816
    ds_read_b64_tr_b16 v[100:101], v121 offset:49152
    ds_read_b64_tr_b16 v[102:103], v121 offset:51200
    s_waitcnt lgkmcnt(2)
    v_mfma_f32_16x16x32_bf16 v[104:107], v[96:99], v[32:35], v[104:107]
    v_mfma_f32_16x16x32_bf16 v[108:111], v[96:99], v[64:67], v[108:111]
    v_mfma_f32_16x16x32_bf16 v[112:115], v[96:99], v[88:91], v[112:115]
    s_waitcnt lgkmcnt(0)
    v_mfma_f32_16x16x32_bf16 v[104:107], v[100:103], v[36:39], v[104:107]
    v_mfma_f32_16x16x32_bf16 v[108:111], v[100:103], v[68:71], v[108:111]
    v_mfma_f32_16x16x32_bf16 v[112:115], v[100:103], v[92:95], v[112:115]
    ds_read_b128 v[88:91], v2 offset:16640
    ds_read_b128 v[92:95], v3 offset:16640
    s_lshl_b32 s38, s3, 14
    s_add_u32 s38, s38, 7340032
    s_waitcnt vmcnt(1)
    s_cmp_eq_u32 s39, 1
    s_cbranch_scc1 L_recs_ok
    s_mov_b32 s91, 0
L_offs_chk:
    v_xor_b32 v23, s56, v20
    v_cmp_ne_u32 vcc, s52, v21
    s_mov_b32 s89, 0x100000
    v_cmp_le_u32 s[40:41], s89, v23
    s_nop 1
    s_or_b64 vcc, vcc, s[40:41]
    s_and_b64 vcc, vcc, s[80:81]
    s_cbranch_scc0 L_offs_ok
    s_add_u32 s91, s91, 1
    s_cmp_gt_u32 s91, 200000
    s_cbranch_scc1 L_offs_ok
    s_and_b32 s90, s2, 7
    s_lshl_b32 s90, s90, 8
    s_and_b32 s89, s2, 0xf8
    s_add_u32 s90, s90, s89
    s_add_u32 s90, s90, 65536
    buffer_load_dwordx2 v[20:21], v22, s[16:19], s90 offen sc1
    s_waitcnt vmcnt(0)
    s_branch L_offs_chk
L_offs_ok:
    v_cndmask_b32 v20, 0, v23, s[80:81]
    v_and_b32 v23, 3, v0
    v_mul_u32_u24 v22, 5120, v10
    v_and_b32 v16, 0x3ff, v20
    v_bfe_u32 v17, v20, 10, 10
    v_add_u32 v16, v16, v23
    v_lshl_add_u32 v22, v16, 3, v22
    v_add_u32 v10, 589824, v22
    v_sub_u32 v11, v17, v23
    v_cmp_lt_u32 vcc, 16, v17
    s_cbranch_vccz L_nomax_11
    v_mov_b32 v16, 161024
    s_mov_b64 exec, vcc
    ds_max_u32 v16, v17
    s_mov_b64 exec, -1
    s_waitcnt lgkmcnt(0)
L_nomax_11:
    s_lshl_b32 s88, s75, 2
    s_lshl_b32 s89, s75, 5
    v_mov_b32 v18, 2147483648
    s_add_u32 s90, s88, 4
    s_add_u32 s91, s88, 8
    v_cmp_lt_i32 s[80:81], s88, v11
    s_add_u32 s88, s88, 12
    v_cmp_lt_i32 s[82:83], s90, v11
    v_cmp_lt_i32 s[84:85], s91, v11
    v_cmp_lt_i32 s[86:87], s88, v11
    s_cmp_gt_u32 s76, 1
    s_cselect_b64 s[82:83], s[82:83], 0
    s_cselect_b64 s[84:85], s[84:85], 0
    s_cselect_b64 s[86:87], s[86:87], 0
    s_cmp_eq_u64 s[84:85], 0
    s_cbranch_scc1 L_hp_12
    v_cndmask_b32 v14, v18, v10, s[84:85]
    buffer_load_dwordx2 v[124:125], v14, s[16:19], s89 offen offset:64 sc1
    v_cndmask_b32 v15, v18, v10, s[86:87]
    buffer_load_dwordx2 v[126:127], v15, s[16:19], s89 offen offset:96 sc1
L_hp_12:
    v_cndmask_b32 v12, v18, v10, s[80:81]
    buffer_load_dwordx2 v[116:117], v12, s[16:19], s89 offen offset:0 sc1
    v_cndmask_b32 v13, v18, v10, s[82:83]
    buffer_load_dwordx2 v[118:119], v13, s[16:19], s89 offen offset:32 sc1
    s_waitcnt vmcnt(0)
L_recs_ok:
    s_mov_b32 s74, 0
L_clean_13:
    s_mov_b64 s[40:41], 0
    s_mov_b64 exec, s[80:81]
    v_xor_b32 v116, s29, v116
    v_xor_b32 v117, s31, v117
    v_lshrrev_b32 v12, 24, v116
    v_lshl_or_b32 v12, v117, 16, v12
    v_cmp_ne_u32 vcc, 0, v12
    s_or_b64 s[40:41], s[40:41], vcc
    s_mov_b64 exec, s[82:83]
    v_xor_b32 v118, s29, v118
    v_xor_b32 v119, s31, v119
    v_lshrrev_b32 v13, 24, v118
    v_lshl_or_b32 v13, v119, 16, v13
    v_cmp_ne_u32 vcc, 0, v13
    s_or_b64 s[40:41], s[40:41], vcc
    s_cmp_eq_u64 s[84:85], 0
    s_cbranch_scc1 L_hp_15
    s_mov_b64 exec, s[84:85]
    v_xor_b32 v124, s29, v124
    v_xor_b32 v125, s31, v125
    v_lshrrev_b32 v14, 24, v124
    v_lshl_or_b32 v14, v125, 16, v14
    v_cmp_ne_u32 vcc, 0, v14
    s_or_b64 s[40:41], s[40:41], vcc
    s_mov_b64 exec, s[86:87]
    v_xor_b32 v126, s29, v126
    v_xor_b32 v127, s31, v127
    v_lshrrev_b32 v15, 24, v126
    v_lshl_or_b32 v15, v127, 16, v15
    v_cmp_ne_u32 vcc, 0, v15
    s_or_b64 s[40:41], s[40:41], vcc
L_hp_15:
    s_mov_b64 exec, -1
    s_cmp_eq_u64 s[40:41], 0
    s_cbranch_scc1 L_cleanok_14
    s_add_u32 s74, s74, 1
    s_cmp_gt_u32 s74, 200000
    s_cbranch_scc1 L_cleanok_14
    s_lshl_b32 s88, s75, 2
    s_lshl_b32 s89, s75, 5
    v_mov_b32 v20, 2147483648
    s_add_u32 s90, s88, 4
    s_add_u32 s91, s88, 8
    v_cmp_lt_i32 s[80:81], s88, v11
    s_add_u32 s88, s88, 12
    v_cmp_lt_i32 s[82:83], s90, v11
    v_cmp_lt_i32 s[84:85], s91, v11
    v_cmp_lt_i32 s[86:87], s88, v11
    s_cmp_gt_u32 s76, 1
    s_cselect_b64 s[82:83], s[82:83], 0
    s_cselect_b64 s[84:85], s[84:85], 0
    s_cselect_b64 s[86:87], s[86:87], 0
    s_cmp_eq_u64 s[84:85], 0
    s_cbranch_scc1 L_hp_16
    v_cndmask_b32 v14, v20, v10, s[84:85]
    buffer_load_dwordx2 v[124:125], v14, s[16:19], s89 offen offset:64 sc1
    v_cndmask_b32 v15, v20, v10, s[86:87]
    buffer_load_dwordx2 v[126:127], v15, s[16:19], s89 offen offset:96 sc1
L_hp_16:
    v_cndmask_b32 v12, v20, v10, s[80:81]
    buffer_load_dwordx2 v[116:117], v12, s[16:19], s89 offen offset:0 sc1
    v_cndmask_b32 v13, v20, v10, s[82:83]
    buffer_load_dwordx2 v[118:119], v13, s[16:19], s89 offen offset:32 sc1
    s_waitcnt vmcnt(0)
    s_branch L_clean_13
L_cleanok_14:
    v_mov_b32 v20, 1
    s_mov_b32 s88, 160768
    s_mov_b64 exec, s[80:81]
    v_bfe_u32 v12, v116, 16, 6
    v_lshl_add_u32 v12, v12, 2, s88
    ds_add_rtn_u32 v16, v12, v20
    s_mov_b64 exec, s[82:83]
    v_bfe_u32 v13, v118, 16, 6
    v_lshl_add_u32 v13, v13, 2, s88
    ds_add_rtn_u32 v17, v13, v20
    s_cmp_eq_u64 s[84:85], 0
    s_cbranch_scc1 L_hp_17
    s_mov_b64 exec, s[84:85]
    v_bfe_u32 v14, v124, 16, 6
    v_lshl_add_u32 v14, v14, 2, s88
    ds_add_rtn_u32 v18, v14, v20
    s_mov_b64 exec, s[86:87]
    v_bfe_u32 v15, v126, 16, 6
    v_lshl_add_u32 v15, v15, 2, s88
    ds_add_rtn_u32 v19, v15, v20
L_hp_17:
    s_mov_b64 exec, -1
    s_add_u32 m0, s62, 0
    s_add_u32 s89, s49, 196608
    buffer_load_dwordx4 v120, s[8:11], s89 offen lds
    s_add_u32 m0, s62, 16384
    s_add_u32 s89, s49, 212992
    buffer_load_dwordx4 v120, s[8:11], s89 offen lds
    s_add_u32 m0, s62, 98304
    s_add_u32 s89, s49, 229376
    buffer_load_dwordx4 v120, s[8:11], s89 offen lds
    s_add_u32 m0, s62, 114688
    s_add_u32 s89, s49, 245760
    buffer_load_dwordx4 v120, s[8:11], s89 offen lds
    s_waitcnt lgkmcnt(0)
    s_barrier
    s_waitcnt vmcnt(4)
    v_cmp_ne_u64 vcc, s[52:53], v[24:25]
    s_nop 1
    s_and_b32 s30, vcc_lo, 0xffff
    v_lshlrev_b32 v120, 4, v1
    s_cmp_eq_u32 s30, 0
    s_cbranch_scc1 L_tags_ok
    s_mov_b32 s91, 0
L_tags:
    v_lshlrev_b32 v26, 5, v1
    s_lshl_b32 s90, s3, 9
    s_add_u32 s90, s90, 4096
    s_mov_b64 exec, 0xffff
    buffer_load_dwordx2 v[24:25], v26, s[16:19], s90 offen sc1
    s_mov_b64 exec, -1
    s_add_u32 s91, s91, 1
    s_cmp_gt_u32 s91, 200000
    s_waitcnt vmcnt(0)
    s_cbranch_scc1 L_tags_ok
    v_cmp_ne_u64 vcc, s[52:53], v[24:25]
    s_nop 1
    s_and_b32 s30, vcc_lo, 0xffff
    s_cbranch_scc1 L_tags
L_tags_ok:
    s_add_u32 s89, s38, 0
    buffer_load_dwordx4 v[24:27], v120, s[16:19], s89 offen sc1
    s_add_u32 s89, s38, 1024
    buffer_load_dwordx4 v[28:31], v120, s[16:19], s89 offen sc1
    s_mov_b32 s88, 160768
    v_lshl_add_u32 v23, v1, 2, s88
    v_mov_b32 v22, 161024
    ds_read_b32 v20, v23
    ds_read_b32 v22, v22
    s_waitcnt lgkmcnt(0)
    v_mov_b32 v21, v20
    v_readfirstlane_b32 s77, v22
    v_cmp_eq_u32 s[6:7], 0, v20
    v_subrev_u32 v20, 157824, v20
    v_add_u32_dpp v21, v21, v21 row_shr:1 row_mask:0xf bank_mask:0xf bound_ctrl:0
    s_nop 1
    v_add_u32_dpp v21, v21, v21 row_shr:2 row_mask:0xf bank_mask:0xf bound_ctrl:0
    s_nop 1
    v_add_u32_dpp v21, v21, v21 row_shr:4 row_mask:0xf bank_mask:0xf bound_ctrl:0
    s_nop 1
    v_add_u32_dpp v21, v21, v21 row_shr:8 row_mask:0xf bank_mask:0xf bound_ctrl:0
    s_nop 1
    v_add_u32_dpp v21, v21, v21 row_bcast:15 row_mask:0xa bank_mask:0xf
    s_nop 1
    v_add_u32_dpp v21, v21, v21 row_bcast:31 row_mask:0xc bank_mask:0xf
    s_nop 0
    v_readlane_b32 s74, v21, 63
    v_sub_u32 v21, v21, v20
    s_cmp_gt_u32 s74, 1024
    s_cbranch_scc1 L_gen1
    s_cmp_eq_u32 s77, 0
    s_cbranch_scc0 L_gen1
    s_cmp_lt_u32 s74, 64
    s_cbranch_scc0 L_lists_18
    s_mov_b32 s79, 2
L_lists_18:
    ds_bpermute_b32 v12, v12, v21
    ds_bpermute_b32 v13, v13, v21
    s_cmp_eq_u64 s[84:85], 0
    s_cbranch_scc1 L_hp_19
    ds_bpermute_b32 v14, v14, v21
    ds_bpermute_b32 v15, v15, v21
L_hp_19:
    s_add_u32 s88, s74, 1
    s_lshr_b32 s88, s88, 1
    s_mul_i32 s89, s88, s3
    s_add_u32 s90, s89, s88
    s_lshr_b32 s66, s89, 4
    s_lshr_b32 s90, s90, 4
    s_sub_u32 s68, s90, s66
    s_lshl_b32 s90, s90, 1
    s_cmp_lt_u32 s90, s74
    s_cselect_b32 s48, 1, 0
    s_min_u32 s90, s90, s74
    s_lshl_b32 s66, s66, 1
    s_sub_u32 s67, s90, s66
    s_mov_b32 s88, 4294803200
    s_mov_b32 s89, 4294489664
    s_waitcnt lgkmcnt(0)
    s_mov_b64 exec, s[80:81]
    v_add_u32 v16, v16, v12
    v_lshl_add_u32 v12, v16, 1, s88
    v_lshl_add_u32 v20, v16, 2, s89
    ds_write_b8_d16_hi v16, v116
    ds_write_b16 v12, v116
    ds_write_b32 v20, v117
    s_mov_b64 exec, s[82:83]
    v_add_u32 v17, v17, v13
    v_lshl_add_u32 v13, v17, 1, s88
    v_lshl_add_u32 v21, v17, 2, s89
    ds_write_b8_d16_hi v17, v118
    ds_write_b16 v13, v118
    ds_write_b32 v21, v119
    s_cmp_eq_u64 s[84:85], 0
    s_cbranch_scc1 L_hp_20
    s_mov_b64 exec, s[84:85]
    v_add_u32 v18, v18, v14
    v_lshl_add_u32 v14, v18, 1, s88
    v_lshl_add_u32 v20, v18, 2, s89
    ds_write_b8_d16_hi v18, v124
    ds_write_b16 v14, v124
    ds_write_b32 v20, v125
    s_mov_b64 exec, s[86:87]
    v_add_u32 v19, v19, v15
    v_lshl_add_u32 v15, v19, 1, s88
    v_lshl_add_u32 v21, v19, 2, s89
    ds_write_b8_d16_hi v19, v126
    ds_write_b16 v15, v126
    ds_write_b32 v21, v127
L_hp_20:
    s_mov_b64 exec, -1
L_gen1_back:
    v_mov_b64 v[22:23], -1
    s_lshl_b32 s88, s3, 9
    s_add_u32 s88, s88, 41984
    v_lshl_add_u32 v15, v1, 3, s88
    ds_write_b64 v15, v[22:23]
    s_add_u32 s89, s38, 2048
    buffer_load_dwordx4 v[32:35], v120, s[16:19], s89 offen sc1
    s_add_u32 s89, s38, 3072
    buffer_load_dwordx4 v[36:39], v120, s[16:19], s89 offen sc1
    s_waitcnt vmcnt(6)
    s_waitcnt lgkmcnt(0)
    s_barrier
    ds_read_b64_tr_b16 v[96:97], v121 offset:0
    ds_read_b64_tr_b16 v[98:99], v121 offset:2048
    ds_read_b64_tr_b16 v[100:101], v121 offset:16384
    ds_read_b64_tr_b16 v[102:103], v121 offset:18432
    s_waitcnt lgkmcnt(2)
    v_mfma_f32_16x16x32_bf16 v[104:107], v[96:99], v[40:43], v[104:107]
    v_mfma_f32_16x16x32_bf16 v[108:111], v[96:99], v[72:75], v[108:111]
    v_mfma_f32_16x16x32_bf16 v[112:115], v[96:99], v[88:91], v[112:115]
    s_waitcnt lgkmcnt(0)
    v_mfma_f32_16x16x32_bf16 v[104:107], v[100:103], v[44:47], v[104:107]
    v_mfma_f32_16x16x32_bf16 v[108:111], v[100:103], v[76:79], v[108:111]
    v_mfma_f32_16x16x32_bf16 v[112:115], v[100:103], v[92:95], v[112:115]
    ds_read_b128 v[88:91], v4 offset:16640
    ds_read_b128 v[92:95], v5 offset:16640
    s_cmp_eq_u32 s3, 0
    s_cbranch_scc0 L_w0_21
    v_lshlrev_b32 v14, 5, v1
    s_mov_b32 s89, 12288
    s_mov_b32 s91, 16384
    buffer_load_dwordx2 v[16:17], v14, s[16:19], s89 offen offset:0 sc1
    buffer_load_dwordx2 v[18:19], v14, s[16:19], s89 offen offset:2048 sc1
    buffer_load_dwordx2 v[20:21], v14, s[16:19], s91 offen offset:0 sc1
    buffer_load_dwordx2 v[22:23], v14, s[16:19], s91 offen offset:2048 sc1
L_w0_21:
    s_mov_b32 s89, 161088
    v_lshl_add_u32 v15, v1, 1, s89
    ds_read_u16_d16_hi v124, v15 offset:0
    ds_read_u16_d16_hi v125, v15 offset:128
    ds_read_u16_d16_hi v126, v15 offset:256
    ds_read_u16_d16_hi v127, v15 offset:384
    s_add_u32 s89, s38, 4096
    buffer_load_dwordx4 v[40:43], v120, s[16:19], s89 offen sc1
    s_add_u32 s89, s38, 5120
    buffer_load_dwordx4 v[44:47], v120, s[16:19], s89 offen sc1
    s_add_u32 s91, s66, 157823
    v_add_u32 v118, s91, v1
    s_lshl_b32 s88, s66, 1
    s_add_u32 s88, s88, 151552
    v_lshl_add_u32 v117, v1, 1, s88
    ds_read_u16 v72, v117
    ds_read_u8 v69, v118
    ds_read_u8 v71, v118 offset:1
    ds_read_u8 v70, v118 offset:2
    s_cmp_lt_u32 s3, 9
    s_mov_b32 s90, 160384
    s_cselect_b32 s90, 158880, s90
    s_mul_i32 s89, s3, 192
    s_add_u32 s89, s89, s90
    v_lshl_add_u32 v118, v1, 1, s89
    v_mov_b32 v73, 0xffff
    v_cmp_gt_i32 vcc, s67, v1
    s_mov_b32 exec_hi, 0
    ds_write_b16 v118, v73 offset:128
    s_mov_b64 exec, -1
    v_lshrrev_b32 v116, 5, v1
    v_lshl_add_u32 v116, v116, 1, s89
    s_lshl_b32 s88, s66, 2
    s_add_u32 s88, s88, 153664
    v_mov_b32 v117, s88
    s_waitcnt lgkmcnt(4)
    v_cndmask_b32 v72, v73, v72, vcc
    ds_write_b16 v118, v72
    ds_read_u16 v64, v116 offset:0
    ds_read_u16 v65, v116 offset:4
    ds_read_u16 v66, v116 offset:8
    ds_read_u16 v67, v116 offset:12
    ds_read_u16 v68, v116 offset:16
    s_waitcnt lgkmcnt(7)
    v_cmp_ne_u32 s[64:65], v71, v70
    v_cmp_eq_u32 vcc, v71, v69
    v_mul_u32_u24 v118, 1040, v71
    v_and_b32 v70, 15, v71
    v_lshlrev_b32 v70, 4, v70
    v_lshl_add_u32 v70, v71, 9, v70
    v_lshl_or_b32 v118, v70, 16, v118
    s_sub_u32 s88, s67, 1
    s_bitcmp0_b64 s[64:65], s88
    s_cselect_b32 s48, s48, 0
    s_bitset1_b64 s[64:65], s88
    v_readfirstlane_b32 s89, v118
    s_lshr_b32 s69, s65, 31
    s_lshl_b32 s69, s69, 24
    s_lshl_b64 s[64:65], s[64:65], 1
    s_and_b32 s90, vcc_lo, 1
    s_cmp_eq_u32 s66, 0
    s_cselect_b32 s90, 0, s90
    s_cmp_lt_u32 s79, 2
    s_cselect_b32 s90, s90, 0
    s_lshl_b32 s88, s3, 9
    s_add_u32 s88, s88, 173056
    s_lshr_b32 s91, s89, 16
    s_cmp_eq_u32 s90, 0
    s_cselect_b32 s45, s91, s88
    s_and_b32 s44, s89, 0xffff
    s_add_u32 s89, s38, 6144
    buffer_load_dwordx4 v[56:59], v120, s[16:19], s89 offen sc1
    s_add_u32 s89, s38, 7168
    buffer_load_dwordx4 v[60:63], v120, s[16:19], s89 offen sc1
    v_and_b32 v75, 15, v1
    v_cmp_gt_u32 s[42:43], 8, v75
    v_mul_u32_u24 v74, 1040, v75
    v_and_b32 v75, 48, v1
    s_lshl_b32 s89, s3, 6
    v_add3_u32 v74, v74, v75, s89
    s_lshl_b32 s88, s3, 11
    s_add_u32 s70, s88, 65536
    s_add_u32 s71, s88, 66560
    s_add_u32 s72, s88, 98304
    s_add_u32 s73, s88, 99328
    v_and_b32 v77, 31, v1
    v_lshlrev_b32 v77, 4, v77
    s_cmp_eq_u32 s3, 0
    s_cbranch_scc0 L_w0_22
    s_mov_b32 s90, 0
    s_branch L_pchk_24
L_poll_23:
    v_lshlrev_b32 v14, 5, v1
    s_mov_b32 s89, 12288
    s_mov_b32 s91, 16384
    buffer_load_dwordx2 v[16:17], v14, s[16:19], s89 offen offset:0 sc1
    buffer_load_dwordx2 v[18:19], v14, s[16:19], s89 offen offset:2048 sc1
    buffer_load_dwordx2 v[20:21], v14, s[16:19], s91 offen offset:0 sc1
    buffer_load_dwordx2 v[22:23], v14, s[16:19], s91 offen offset:2048 sc1
L_pchk_24:
    s_waitcnt vmcnt(0)
    v_cmp_ne_u64 s[40:41], s[52:53], v[16:17]
    v_cmp_ne_u64 vcc, s[52:53], v[18:19]
    v_cmp_ne_u64 s[88:89], s[52:53], v[20:21]
    v_cmp_ne_u64 s[46:47], s[52:53], v[22:23]
    s_nop 1
    s_and_b32 s47, s47, 67108863
    s_or_b64 s[40:41], s[40:41], vcc
    s_or_b64 s[46:47], s[88:89], s[46:47]
    s_or_b64 s[40:41], s[40:41], s[46:47]
    s_cbranch_scc0 L_pdone_25
    s_add_u32 s90, s90, 1
    s_cmp_lt_u32 s90, 200000
    s_cbranch_scc1 L_poll_23
L_pdone_25:
    s_cmp_eq_u32 s2, 0
    s_cbranch_scc0 L_noep
    s_mov_b32 s89, 0
    v_mov_b32 v16, s52
    v_mov_b32 v17, s53
    v_lshlrev_b32 v18, 24, v1
    buffer_store_dwordx2 v[16:17], v18, s[16:19], s89 offen sc1
L_noep:
L_w0_22:
    s_waitcnt vmcnt(8)
    s_waitcnt lgkmcnt(0)
    s_barrier
    ds_read_b64_tr_b16 v[96:97], v122 offset:32768
    ds_read_b64_tr_b16 v[98:99], v122 offset:34816
    ds_read_b64_tr_b16 v[100:101], v122 offset:49152
    ds_read_b64_tr_b16 v[102:103], v122 offset:51200
    v_mov_b32 v76, v64
    s_mov_b32 m0, s70
    s_nop 0
    buffer_load_dwordx4 v[76:77], s[20:23], 0 idxen offen sc1 lds
    s_waitcnt lgkmcnt(2)
    v_mfma_f32_16x16x32_bf16 v[104:107], v[96:99], v[48:51], v[104:107]
    v_mfma_f32_16x16x32_bf16 v[108:111], v[96:99], v[80:83], v[108:111]
    v_mfma_f32_16x16x32_bf16 v[112:115], v[96:99], v[88:91], v[112:115]
    v_mov_b32 v76, v65
    s_mov_b32 m0, s71
    s_nop 0
    buffer_load_dwordx4 v[76:77], s[20:23], 0 idxen offen sc1 lds
    s_waitcnt lgkmcnt(0)
    v_mfma_f32_16x16x32_bf16 v[104:107], v[100:103], v[52:55], v[104:107]
    v_mfma_f32_16x16x32_bf16 v[108:111], v[100:103], v[84:87], v[108:111]
    v_mfma_f32_16x16x32_bf16 v[112:115], v[100:103], v[92:95], v[112:115]
    ds_read_b128 v[80:83], v2 offset:0
    ds_read_b128 v[84:87], v2 offset:8192
    ds_read_b128 v[88:91], v2 offset:16384
    ds_read_b128 v[92:95], v3 offset:0
    ds_read_b128 v[96:99], v3 offset:8192
    ds_read_b128 v[100:103], v3 offset:16384
    v_pk_mul_f32 v[104:105], v[104:105], s[58:59] op_sel_hi:[1,0]
    v_pk_mul_f32 v[106:107], v[106:107], s[58:59] op_sel_hi:[1,0]
    ds_write_b128 v74, v[104:107] offset:0
    v_pk_mul_f32 v[108:109], v[108:109], s[58:59] op_sel_hi:[1,0]
    v_pk_mul_f32 v[110:111], v[110:111], s[58:59] op_sel_hi:[1,0]
    ds_write_b128 v74, v[108:111] offset:16640
    v_pk_mul_f32 v[112:113], v[112:113], s[58:59] op_sel_hi:[1,0]
    v_pk_mul_f32 v[114:115], v[114:115], s[58:59] op_sel_hi:[1,0]
    s_mov_b64 exec, s[42:43]
    ds_write_b128 v74, v[112:115] offset:33280
    s_mov_b64 exec, -1
    s_waitcnt vmcnt(9)
    s_waitcnt lgkmcnt(6)
    v_mfma_f32_16x16x32_bf16 v[12:15], v[24:27], v[80:83], 0
    v_mfma_f32_16x16x32_bf16 v[16:19], v[24:27], v[84:87], 0
    v_mfma_f32_16x16x32_bf16 v[20:23], v[24:27], v[88:91], 0
    ds_read_b128 v[80:83], v4 offset:0
    ds_read_b128 v[84:87], v4 offset:8192
    ds_read_b128 v[88:91], v4 offset:16384
    s_barrier
    s_waitcnt vmcnt(8)
    s_waitcnt lgkmcnt(6)
    v_mfma_f32_16x16x32_bf16 v[12:15], v[28:31], v[92:95], v[12:15]
    v_mfma_f32_16x16x32_bf16 v[16:19], v[28:31], v[96:99], v[16:19]
    v_mfma_f32_16x16x32_bf16 v[20:23], v[28:31], v[100:103], v[20:23]
    ds_read_b128 v[92:95], v5 offset:0
    ds_read_b128 v[96:99], v5 offset:8192
    ds_read_b128 v[100:103], v5 offset:16384
    s_waitcnt vmcnt(7)
    s_waitcnt lgkmcnt(3)
    v_mfma_f32_16x16x32_bf16 v[12:15], v[32:35], v[80:83], v[12:15]
    v_mfma_f32_16x16x32_bf16 v[16:19], v[32:35], v[84:87], v[16:19]
    v_mfma_f32_16x16x32_bf16 v[20:23], v[32:35], v[88:91], v[20:23]
    ds_read_b128 v[80:83], v2 offset:256
    ds_read_b128 v[84:87], v2 offset:8448
    ds_read_b128 v[88:91], v2 offset:16640
    v_mov_b32 v76, v66
    s_mov_b32 m0, s72
    s_nop 0
    buffer_load_dwordx4 v[76:77], s[20:23], 0 idxen offen sc1 lds
    s_waitcnt vmcnt(7)
    s_waitcnt lgkmcnt(3)
    v_mfma_f32_16x16x32_bf16 v[12:15], v[36:39], v[92:95], v[12:15]
    v_mfma_f32_16x16x32_bf16 v[16:19], v[36:39], v[96:99], v[16:19]
    v_mfma_f32_16x16x32_bf16 v[20:23], v[36:39], v[100:103], v[20:23]
    ds_read_b128 v[92:95], v3 offset:256
    ds_read_b128 v[96:99], v3 offset:8448
    ds_read_b128 v[100:103], v3 offset:16640
    s_waitcnt vmcnt(6)
    s_waitcnt lgkmcnt(3)
    v_mfma_f32_16x16x32_bf16 v[12:15], v[40:43], v[80:83], v[12:15]
    v_mfma_f32_16x16x32_bf16 v[16:19], v[40:43], v[84:87], v[16:19]
    v_mfma_f32_16x16x32_bf16 v[20:23], v[40:43], v[88:91], v[20:23]
    ds_read_b128 v[80:83], v4 offset:256
    ds_read_b128 v[84:87], v4 offset:8448
    ds_read_b128 v[88:91], v4 offset:16640
    s_waitcnt vmcnt(5)
    s_waitcnt lgkmcnt(3)
    v_mfma_f32_16x16x32_bf16 v[12:15], v[44:47], v[92:95], v[12:15]
    v_mfma_f32_16x16x32_bf16 v[16:19], v[44:47], v[96:99], v[16:19]
    v_mfma_f32_16x16x32_bf16 v[20:23], v[44:47], v[100:103], v[20:23]
    ds_read_b128 v[92:95], v5 offset:256
    ds_read_b128 v[96:99], v5 offset:8448
    ds_read_b128 v[100:103], v5 offset:16640
    v_mov_b32 v76, v67
    s_mov_b32 m0, s73
    s_nop 0
    buffer_load_dwordx4 v[76:77], s[20:23], 0 idxen offen sc1 lds
    s_waitcnt vmcnt(5)
    s_waitcnt lgkmcnt(3)
    v_mfma_f32_16x16x32_bf16 v[12:15], v[56:59], v[80:83], v[12:15]
    v_mfma_f32_16x16x32_bf16 v[16:19], v[56:59], v[84:87], v[16:19]
    v_mfma_f32_16x16x32_bf16 v[20:23], v[56:59], v[88:91], v[20:23]
    s_waitcnt vmcnt(4)
    s_waitcnt lgkmcnt(0)
    v_mfma_f32_16x16x32_bf16 v[12:15], v[60:63], v[92:95], v[12:15]
    v_mfma_f32_16x16x32_bf16 v[16:19], v[60:63], v[96:99], v[16:19]
    v_mfma_f32_16x16x32_bf16 v[20:23], v[60:63], v[100:103], v[20:23]
    v_mov_b32 v76, v68
    v_mul_f32 v124, s58, v124
    v_mul_f32 v125, s58, v125
    v_mul_f32 v126, s58, v126
    v_mul_f32 v127, s58, v127
    s_nop 0
    v_pk_mul_f32 v[12:13], v[12:13], s[58:59] op_sel_hi:[1,0]
    v_pk_mul_f32 v[14:15], v[14:15], s[58:59] op_sel_hi:[1,0]
    v_pk_mul_f32 v[16:17], v[16:17], s[58:59] op_sel_hi:[1,0]
    v_pk_mul_f32 v[18:19], v[18:19], s[58:59] op_sel_hi:[1,0]
    v_pk_mul_f32 v[20:21], v[20:21], s[58:59] op_sel_hi:[1,0]
    v_pk_mul_f32 v[22:23], v[22:23], s[58:59] op_sel_hi:[1,0]
    v_lshl_add_u32 v82, v1, 1, s70
    v_lshlrev_b32 v83, 2, v1
    v_lshlrev_b32 v84, 3, v1
    v_or_b32 v84, 131072, v84
    s_waitcnt lgkmcnt(0)
    s_barrier
    s_cmp_eq_u32 s57, 0
    s_cbranch_scc0 L_generic
    s_and_b32 s7, s7, 0xff
    s_or_b32 s88, s6, s7
    s_or_b32 s88, s88, s79
    s_cbranch_scc1 L_clear
L_r_done:
    s_cmp_gt_i32 s67, 0
    s_cbranch_scc0 L_empty
    s_setprio 3
    ds_read_b64 v[72:73], v117
    v_add_u32 v112, s44, v83
    ds_read2st64_b32 v[78:79], v112 offset0:0 offset1:1
    ds_read2st64_b32 v[80:81], v112 offset0:2 offset1:3
    v_xor_b32 v113, s45, v84
    v_add_u32 v109, 160768, v83
    v_mov_b32 v115, 0
    ds_write_b32 v109, v115
    v_mov_b64 v[98:99], 0
    v_mov_b64 v[100:101], 0
    v_mov_b32 v102, 1.0
    v_mov_b32 v103, 1.0
    v_mov_b32 v104, 1.0
    v_mov_b32 v105, 1.0
    v_mov_b64 v[106:107], 0
    v_mov_b32 v108, 0
    s_mov_b32 s66, 0
    s_or_b32 s28, s64, 0
    s_mov_b32 s39, -1
    s_waitcnt vmcnt(3)
    ds_read_u16_d16_hi v56, v82 offset:0
    ds_read_u16_d16_hi v57, v82 offset:128
    ds_read_u16_d16_hi v58, v82 offset:256
    ds_read_u16_d16_hi v59, v82 offset:384
    ds_read_u16_d16_hi v60, v82 offset:512
    ds_read_u16_d16_hi v61, v82 offset:640
    ds_read_u16_d16_hi v62, v82 offset:768
    ds_read_u16_d16_hi v63, v82 offset:896
    s_waitcnt lgkmcnt(0)
    s_mov_b32 m0, s70
    s_nop 0
    buffer_load_dwordx4 v[76:77], s[20:23], 0 idxen offen sc1 lds
    s_cmp_eq_u32 s79, 0
    s_cbranch_scc0 L_enter_x
L_loop_f:
    s_and_b32 s88, s28, 3
    s_cbranch_scc1 L_blk_f_0
    s_waitcnt vmcnt(3)
    ds_read_u16_d16_hi v64, v82 offset:1024
    ds_read_u16_d16_hi v65, v82 offset:1152
    ds_read_u16_d16_hi v66, v82 offset:1280
    ds_read_u16_d16_hi v67, v82 offset:1408
    ds_read_u16_d16_hi v68, v82 offset:1536
    ds_read_u16_d16_hi v69, v82 offset:1664
    ds_read_u16_d16_hi v70, v82 offset:1792
    ds_read_u16_d16_hi v71, v82 offset:1920
    ds_read_b64 v[74:75], v117 offset:8
    ds_read_u16 v76, v116 offset:20
    v_pk_fma_f32 v[90:91], v[72:73], v[124:125], v[78:79] op_sel:[0,0,0] op_sel_hi:[0,1,1]
    v_pk_fma_f32 v[92:93], v[72:73], v[126:127], v[80:81] op_sel:[0,0,0] op_sel_hi:[0,1,1]
    v_pk_fma_f32 v[86:87], v[72:73], v[124:125], v[78:79] op_sel:[1,0,0] op_sel_hi:[1,1,1]
    v_pk_fma_f32 v[88:89], v[72:73], v[126:127], v[80:81] op_sel:[1,0,0] op_sel_hi:[1,1,1]
    v_pk_add_f32 v[90:91], v[56:57], v[90:91]
    v_pk_add_f32 v[92:93], v[58:59], v[92:93]
    v_pk_add_f32 v[86:87], v[60:61], v[86:87]
    v_pk_add_f32 v[88:89], v[62:63], v[88:89]
    v_exp_f32 v94, v90
    v_exp_f32 v95, v91
    v_exp_f32 v96, v92
    v_exp_f32 v97, v93
    v_exp_f32 v56, v86
    v_exp_f32 v57, v87
    v_pk_fma_f32 v[98:99], v[98:99], v[94:95], v[98:99]
    v_pk_fma_f32 v[100:101], v[100:101], v[96:97], v[100:101]
    v_exp_f32 v58, v88
    v_pk_fma_f32 v[98:99], v[90:91], v[102:103], v[98:99]
    v_pk_fma_f32 v[100:101], v[92:93], v[104:105], v[100:101]
    v_exp_f32 v59, v89
    v_pk_fma_f32 v[102:103], v[102:103], v[94:95], v[102:103]
    v_pk_fma_f32 v[104:105], v[104:105], v[96:97], v[104:105]
    v_pk_fma_f32 v[98:99], v[98:99], v[56:57], v[98:99]
    v_pk_fma_f32 v[100:101], v[100:101], v[58:59], v[100:101]
    v_pk_fma_f32 v[98:99], v[86:87], v[102:103], v[98:99]
    v_pk_fma_f32 v[100:101], v[88:89], v[104:105], v[100:101]
    v_pk_fma_f32 v[102:103], v[102:103], v[56:57], v[102:103]
    v_pk_fma_f32 v[104:105], v[104:105], v[58:59], v[104:105]
L_back_f_0:
    s_mov_b32 m0, s71
    s_waitcnt lgkmcnt(0)
    buffer_load_dwordx4 v[76:77], s[20:23], 0 idxen offen sc1 lds
    s_and_b32 s88, s28, 12
    s_cbranch_scc1 L_blk_f_1
    s_waitcnt vmcnt(3)
    ds_read_u16_d16_hi v56, v82 offset:32768
    ds_read_u16_d16_hi v57, v82 offset:32896
    ds_read_u16_d16_hi v58, v82 offset:33024
    ds_read_u16_d16_hi v59, v82 offset:33152
    ds_read_u16_d16_hi v60, v82 offset:33280
    ds_read_u16_d16_hi v61, v82 offset:33408
    ds_read_u16_d16_hi v62, v82 offset:33536
    ds_read_u16_d16_hi v63, v82 offset:33664
    ds_read_b64 v[72:73], v117 offset:16
    ds_read_u16 v76, v116 offset:24
    v_pk_fma_f32 v[90:91], v[74:75], v[124:125], v[78:79] op_sel:[0,0,0] op_sel_hi:[0,1,1]
    v_pk_fma_f32 v[92:93], v[74:75], v[126:127], v[80:81] op_sel:[0,0,0] op_sel_hi:[0,1,1]
    v_pk_fma_f32 v[86:87], v[74:75], v[124:125], v[78:79] op_sel:[1,0,0] op_sel_hi:[1,1,1]
    v_pk_fma_f32 v[88:89], v[74:75], v[126:127], v[80:81] op_sel:[1,0,0] op_sel_hi:[1,1,1]
    v_pk_add_f32 v[90:91], v[64:65], v[90:91]
    v_pk_add_f32 v[92:93], v[66:67], v[92:93]
    v_pk_add_f32 v[86:87], v[68:69], v[86:87]
    v_pk_add_f32 v[88:89], v[70:71], v[88:89]
    v_exp_f32 v94, v90
    v_exp_f32 v95, v91
    v_exp_f32 v96, v92
    v_exp_f32 v97, v93
    v_exp_f32 v64, v86
    v_exp_f32 v65, v87
    v_pk_fma_f32 v[98:99], v[98:99], v[94:95], v[98:99]
    v_pk_fma_f32 v[100:101], v[100:101], v[96:97], v[100:101]
    v_exp_f32 v66, v88
    v_pk_fma_f32 v[98:99], v[90:91], v[102:103], v[98:99]
    v_pk_fma_f32 v[100:101], v[92:93], v[104:105], v[100:101]
    v_exp_f32 v67, v89
    v_pk_fma_f32 v[102:103], v[102:103], v[94:95], v[102:103]
    v_pk_fma_f32 v[104:105], v[104:105], v[96:97], v[104:105]
    v_pk_fma_f32 v[98:99], v[98:99], v[64:65], v[98:99]
    v_pk_fma_f32 v[100:101], v[100:101], v[66:67], v[100:101]
    v_pk_fma_f32 v[98:99], v[86:87], v[102:103], v[98:99]
    v_pk_fma_f32 v[100:101], v[88:89], v[104:105], v[100:101]
    v_pk_fma_f32 v[102:103], v[102:103], v[64:65], v[102:103]
    v_pk_fma_f32 v[104:105], v[104:105], v[66:67], v[104:105]
L_back_f_1:
    s_mov_b32 m0, s72
    s_waitcnt lgkmcnt(0)
    buffer_load_dwordx4 v[76:77], s[20:23], 0 idxen offen sc1 lds
    s_and_b32 s88, s28, 48
    s_cbranch_scc1 L_blk_f_2
    s_waitcnt vmcnt(3)
    ds_read_u16_d16_hi v64, v82 offset:33792
    ds_read_u16_d16_hi v65, v82 offset:33920
    ds_read_u16_d16_hi v66, v82 offset:34048
    ds_read_u16_d16_hi v67, v82 offset:34176
    ds_read_u16_d16_hi v68, v82 offset:34304
    ds_read_u16_d16_hi v69, v82 offset:34432
    ds_read_u16_d16_hi v70, v82 offset:34560
    ds_read_u16_d16_hi v71, v82 offset:34688
    ds_read_b64 v[74:75], v117 offset:24
    ds_read_u16 v76, v116 offset:28
    v_pk_fma_f32 v[90:91], v[72:73], v[124:125], v[78:79] op_sel:[0,0,0] op_sel_hi:[0,1,1]
    v_pk_fma_f32 v[92:93], v[72:73], v[126:127], v[80:81] op_sel:[0,0,0] op_sel_hi:[0,1,1]
    v_pk_fma_f32 v[86:87], v[72:73], v[124:125], v[78:79] op_sel:[1,0,0] op_sel_hi:[1,1,1]
    v_pk_fma_f32 v[88:89], v[72:73], v[126:127], v[80:81] op_sel:[1,0,0] op_sel_hi:[1,1,1]
    v_pk_add_f32 v[90:91], v[56:57], v[90:91]
    v_pk_add_f32 v[92:93], v[58:59], v[92:93]
    v_pk_add_f32 v[86:87], v[60:61], v[86:87]
    v_pk_add_f32 v[88:89], v[62:63], v[88:89]
    v_exp_f32 v94, v90
    v_exp_f32 v95, v91
    v_exp_f32 v96, v92
    v_exp_f32 v97, v93
    v_exp_f32 v56, v86
    v_exp_f32 v57, v87
    v_pk_fma_f32 v[98:99], v[98:99], v[94:95], v[98:99]
    v_pk_fma_f32 v[100:101], v[100:101], v[96:97], v[100:101]
    v_exp_f32 v58, v88
    v_pk_fma_f32 v[98:99], v[90:91], v[102:103], v[98:99]
    v_pk_fma_f32 v[100:101], v[92:93], v[104:105], v[100:101]
    v_exp_f32 v59, v89
    v_pk_fma_f32 v[102:103], v[102:103], v[94:95], v[102:103]
    v_pk_fma_f32 v[104:105], v[104:105], v[96:97], v[104:105]
    v_pk_fma_f32 v[98:99], v[98:99], v[56:57], v[98:99]
    v_pk_fma_f32 v[100:101], v[100:101], v[58:59], v[100:101]
    v_pk_fma_f32 v[98:99], v[86:87], v[102:103], v[98:99]
    v_pk_fma_f32 v[100:101], v[88:89], v[104:105], v[100:101]
    v_pk_fma_f32 v[102:103], v[102:103], v[56:57], v[102:103]
    v_pk_fma_f32 v[104:105], v[104:105], v[58:59], v[104:105]
L_back_f_2:
    s_mov_b32 m0, s73
    s_waitcnt lgkmcnt(0)
    buffer_load_dwordx4 v[76:77], s[20:23], 0 idxen offen sc1 lds
    s_and_b32 s88, s28, 192
    s_cbranch_scc1 L_blk_f_3
    s_waitcnt vmcnt(3)
    ds_read_u16_d16_hi v56, v82 offset:0
    ds_read_u16_d16_hi v57, v82 offset:128
    ds_read_u16_d16_hi v58, v82 offset:256
    ds_read_u16_d16_hi v59, v82 offset:384
    ds_read_u16_d16_hi v60, v82 offset:512
    ds_read_u16_d16_hi v61, v82 offset:640
    ds_read_u16_d16_hi v62, v82 offset:768
    ds_read_u16_d16_hi v63, v82 offset:896
    ds_read_b64 v[72:73], v117 offset:32
    ds_read_u16 v76, v116 offset:32
    v_pk_fma_f32 v[90:91], v[74:75], v[124:125], v[78:79] op_sel:[0,0,0] op_sel_hi:[0,1,1]
    v_pk_fma_f32 v[92:93], v[74:75], v[126:127], v[80:81] op_sel:[0,0,0] op_sel_hi:[0,1,1]
    v_pk_fma_f32 v[86:87], v[74:75], v[124:125], v[78:79] op_sel:[1,0,0] op_sel_hi:[1,1,1]
    v_pk_fma_f32 v[88:89], v[74:75], v[126:127], v[80:81] op_sel:[1,0,0] op_sel_hi:[1,1,1]
    v_pk_add_f32 v[90:91], v[64:65], v[90:91]
    v_pk_add_f32 v[92:93], v[66:67], v[92:93]
    v_pk_add_f32 v[86:87], v[68:69], v[86:87]
    v_pk_add_f32 v[88:89], v[70:71], v[88:89]
    v_exp_f32 v94, v90
    v_exp_f32 v95, v91
    v_exp_f32 v96, v92
    v_exp_f32 v97, v93
    v_exp_f32 v64, v86
    v_exp_f32 v65, v87
    v_pk_fma_f32 v[98:99], v[98:99], v[94:95], v[98:99]
    v_pk_fma_f32 v[100:101], v[100:101], v[96:97], v[100:101]
    v_exp_f32 v66, v88
    v_pk_fma_f32 v[98:99], v[90:91], v[102:103], v[98:99]
    v_pk_fma_f32 v[100:101], v[92:93], v[104:105], v[100:101]
    v_exp_f32 v67, v89
    v_pk_fma_f32 v[102:103], v[102:103], v[94:95], v[102:103]
    v_pk_fma_f32 v[104:105], v[104:105], v[96:97], v[104:105]
    v_pk_fma_f32 v[98:99], v[98:99], v[64:65], v[98:99]
    v_pk_fma_f32 v[100:101], v[100:101], v[66:67], v[100:101]
    v_pk_fma_f32 v[98:99], v[86:87], v[102:103], v[98:99]
    v_pk_fma_f32 v[100:101], v[88:89], v[104:105], v[100:101]
    v_pk_fma_f32 v[102:103], v[102:103], v[64:65], v[102:103]
    v_pk_fma_f32 v[104:105], v[104:105], v[66:67], v[104:105]
L_back_f_3:
    s_mov_b32 m0, s70
    s_waitcnt lgkmcnt(0)
    buffer_load_dwordx4 v[76:77], s[20:23], 0 idxen offen sc1 lds
    v_add_u32 v116, 16, v116
    v_add_u32 v117, 32, v117
    s_lshr_b64 s[64:65], s[64:65], 8
    s_or_b32 s65, s65, s69
    s_mov_b32 s69, 0
    s_mov_b32 s28, s64
    s_add_u32 s66, s66, 8
    s_sub_u32 s68, s68, 4
    s_cmp_gt_i32 s68, 12
    s_cbranch_scc1 L_loop_f
    s_cmp_gt_i32 s68, 12
    s_cbranch_scc1 L_nou2_f
    s_cmp_eq_u32 s39, -1
    s_cbranch_scc0 L_nou2_f
    s_lshl_b32 s88, s3, 14
    s_add_u32 s88, s88, 7348224
    s_add_u32 s89, s88, 4096
    v_lshlrev_b32 v120, 4, v1
    buffer_load_dwordx4 v[24:27], v120, s[16:19], s88 offen offset:0 sc1
    buffer_load_dwordx4 v[28:31], v120, s[16:19], s88 offen offset:1024 sc1
    buffer_load_dwordx4 v[32:35], v120, s[16:19], s88 offen offset:2048 sc1
    buffer_load_dwordx4 v[36:39], v120, s[16:19], s88 offen offset:3072 sc1
    buffer_load_dwordx4 v[40:43], v120, s[16:19], s89 offen offset:0 sc1
    buffer_load_dwordx4 v[44:47], v120, s[16:19], s89 offen offset:1024 sc1
    buffer_load_dwordx4 v[48:51], v120, s[16:19], s89 offen offset:2048 sc1
    buffer_load_dwordx4 v[52:55], v120, s[16:19], s89 offen offset:3072 sc1
    s_mov_b32 s39, s66
    s_or_b32 s28, s28, 0xff
L_nou2_f:
    s_setprio 2
    s_cmp_gt_i32 s68, 8
    s_cbranch_scc1 L_loop_f
    s_setprio 1
    s_cmp_gt_i32 s68, 4
    s_cbranch_scc1 L_loop_f
    s_setprio 0
    s_branch L_loop_f
L_blk_f_0:
    s_waitcnt vmcnt(11)
    s_cmp_eq_u32 s66, s39
    s_cbranch_scc1 L_blk_f_0_w
    s_waitcnt vmcnt(3)
L_blk_f_0_w:
    ds_read_u16_d16_hi v64, v82 offset:1024
    ds_read_u16_d16_hi v65, v82 offset:1152
    ds_read_u16_d16_hi v66, v82 offset:1280
    ds_read_u16_d16_hi v67, v82 offset:1408
    ds_read_u16_d16_hi v68, v82 offset:1536
    ds_read_u16_d16_hi v69, v82 offset:1664
    ds_read_u16_d16_hi v70, v82 offset:1792
    ds_read_u16_d16_hi v71, v82 offset:1920
    ds_read_b64 v[74:75], v117 offset:8
    ds_read_u16 v76, v116 offset:20
    s_bitcmp1_b32 s64, 0
    s_cbranch_scc1 L_blk_f_0_f0
    v_pk_fma_f32 v[86:87], v[72:73], v[124:125], v[78:79] op_sel:[0,0,0] op_sel_hi:[0,1,1]
    v_pk_fma_f32 v[88:89], v[72:73], v[126:127], v[80:81] op_sel:[0,0,0] op_sel_hi:[0,1,1]
    v_pk_add_f32 v[90:91], v[56:57], v[86:87]
    v_pk_add_f32 v[92:93], v[58:59], v[88:89]
    v_exp_f32 v94, v90
    v_exp_f32 v95, v91
    v_exp_f32 v96, v92
    v_exp_f32 v97, v93
    v_pk_fma_f32 v[98:99], v[98:99], v[94:95], v[98:99]
    v_pk_fma_f32 v[100:101], v[100:101], v[96:97], v[100:101]
    v_pk_fma_f32 v[98:99], v[90:91], v[102:103], v[98:99]
    v_pk_fma_f32 v[100:101], v[92:93], v[104:105], v[100:101]
    v_pk_fma_f32 v[102:103], v[102:103], v[94:95], v[102:103]
    v_pk_fma_f32 v[104:105], v[104:105], v[96:97], v[104:105]
L_blk_f_0_a:
    s_bitcmp1_b32 s64, 1
    s_cbranch_scc1 L_blk_f_0_f1
    v_pk_fma_f32 v[86:87], v[72:73], v[124:125], v[78:79] op_sel:[1,0,0] op_sel_hi:[1,1,1]
    v_pk_fma_f32 v[88:89], v[72:73], v[126:127], v[80:81] op_sel:[1,0,0] op_sel_hi:[1,1,1]
    v_pk_add_f32 v[90:91], v[60:61], v[86:87]
    v_pk_add_f32 v[92:93], v[62:63], v[88:89]
    v_exp_f32 v94, v90
    v_exp_f32 v95, v91
    v_exp_f32 v96, v92
    v_exp_f32 v97, v93
    v_pk_fma_f32 v[98:99], v[98:99], v[94:95], v[98:99]
    v_pk_fma_f32 v[100:101], v[100:101], v[96:97], v[100:101]
    v_pk_fma_f32 v[98:99], v[90:91], v[102:103], v[98:99]
    v_pk_fma_f32 v[100:101], v[92:93], v[104:105], v[100:101]
    v_pk_fma_f32 v[102:103], v[102:103], v[94:95], v[102:103]
    v_pk_fma_f32 v[104:105], v[104:105], v[96:97], v[104:105]
    s_branch L_back_f_0
L_blk_f_0_f0:
    s_add_u32 s88, s66, 0
    s_cmp_eq_u32 s88, s67
    s_cbranch_scc1 L_fin_f
    v_readlane_b32 s89, v118, s88
    v_rcp_f32 v94, v102
    v_rcp_f32 v95, v103
    v_rcp_f32 v96, v104
    v_rcp_f32 v97, v105
    s_and_b32 s90, s89, 0xffff
    s_lshr_b32 s91, s89, 16
    v_add_u32 v112, s90, v83
    ds_read2st64_b32 v[78:79], v112 offset0:0 offset1:1
    ds_read2st64_b32 v[80:81], v112 offset0:2 offset1:3
    v_max3_f32 v108, v108, v102, v103
    v_max3_f32 v108, v108, v104, v105
    v_pk_mul_f32 v[90:91], v[98:99], v[94:95]
    v_pk_mul_f32 v[92:93], v[100:101], v[96:97]
    v_pk_fma_f32 v[106:107], v[90:91], 0, v[106:107] op_sel_hi:[1,0,1]
    v_pk_fma_f32 v[106:107], v[92:93], 0, v[106:107] op_sel_hi:[1,0,1]
    v_cvt_pk_bf16_f32 v94, v90, v91
    v_cvt_pk_bf16_f32 v95, v92, v93
    ds_write_b64 v113, v[94:95]
    v_xor_b32 v113, s91, v84
    s_waitcnt lgkmcnt(1)
    v_pk_fma_f32 v[86:87], v[72:73], v[124:125], v[78:79] op_sel:[0,0,0] op_sel_hi:[0,1,1]
    v_pk_fma_f32 v[88:89], v[72:73], v[126:127], v[80:81] op_sel:[0,0,0] op_sel_hi:[0,1,1]
    v_pk_add_f32 v[98:99], v[56:57], v[86:87]
    v_pk_add_f32 v[100:101], v[58:59], v[88:89]
    v_exp_f32 v94, v98
    v_exp_f32 v95, v99
    v_exp_f32 v96, v100
    v_exp_f32 v97, v101
    v_pk_add_f32 v[102:103], v[94:95], 1.0 op_sel_hi:[1,0]
    v_pk_add_f32 v[104:105], v[96:97], 1.0 op_sel_hi:[1,0]
    s_branch L_blk_f_0_a
L_blk_f_0_f1:
    s_add_u32 s88, s66, 1
    s_cmp_eq_u32 s88, s67
    s_cbranch_scc1 L_fin_f
    v_readlane_b32 s89, v118, s88
    v_rcp_f32 v94, v102
    v_rcp_f32 v95, v103
    v_rcp_f32 v96, v104
    v_rcp_f32 v97, v105
    s_and_b32 s90, s89, 0xffff
    s_lshr_b32 s91, s89, 16
    v_add_u32 v112, s90, v83
    ds_read2st64_b32 v[78:79], v112 offset0:0 offset1:1
    ds_read2st64_b32 v[80:81], v112 offset0:2 offset1:3
    v_max3_f32 v108, v108, v102, v103
    v_max3_f32 v108, v108, v104, v105
    v_pk_mul_f32 v[90:91], v[98:99], v[94:95]
    v_pk_mul_f32 v[92:93], v[100:101], v[96:97]
    v_pk_fma_f32 v[106:107], v[90:91], 0, v[106:107] op_sel_hi:[1,0,1]
    v_pk_fma_f32 v[106:107], v[92:93], 0, v[106:107] op_sel_hi:[1,0,1]
    v_cvt_pk_bf16_f32 v94, v90, v91
    v_cvt_pk_bf16_f32 v95, v92, v93
    ds_write_b64 v113, v[94:95]
    v_xor_b32 v113, s91, v84
    s_waitcnt lgkmcnt(1)
    v_pk_fma_f32 v[86:87], v[72:73], v[124:125], v[78:79] op_sel:[1,0,0] op_sel_hi:[1,1,1]
    v_pk_fma_f32 v[88:89], v[72:73], v[126:127], v[80:81] op_sel:[1,0,0] op_sel_hi:[1,1,1]
    v_pk_add_f32 v[98:99], v[60:61], v[86:87]
    v_pk_add_f32 v[100:101], v[62:63], v[88:89]
    v_exp_f32 v94, v98
    v_exp_f32 v95, v99
    v_exp_f32 v96, v100
    v_exp_f32 v97, v101
    v_pk_add_f32 v[102:103], v[94:95], 1.0 op_sel_hi:[1,0]
    v_pk_add_f32 v[104:105], v[96:97], 1.0 op_sel_hi:[1,0]
    s_branch L_back_f_0
L_blk_f_1:
    s_waitcnt vmcnt(11)
    s_cmp_eq_u32 s66, s39
    s_cbranch_scc1 L_blk_f_1_w
    s_waitcnt vmcnt(3)
L_blk_f_1_w:
    ds_read_u16_d16_hi v56, v82 offset:32768
    ds_read_u16_d16_hi v57, v82 offset:32896
    ds_read_u16_d16_hi v58, v82 offset:33024
    ds_read_u16_d16_hi v59, v82 offset:33152
    ds_read_u16_d16_hi v60, v82 offset:33280
    ds_read_u16_d16_hi v61, v82 offset:33408
    ds_read_u16_d16_hi v62, v82 offset:33536
    ds_read_u16_d16_hi v63, v82 offset:33664
    ds_read_b64 v[72:73], v117 offset:16
    ds_read_u16 v76, v116 offset:24
    s_bitcmp1_b32 s64, 2
    s_cbranch_scc1 L_blk_f_1_f0
    v_pk_fma_f32 v[86:87], v[74:75], v[124:125], v[78:79] op_sel:[0,0,0] op_sel_hi:[0,1,1]
    v_pk_fma_f32 v[88:89], v[74:75], v[126:127], v[80:81] op_sel:[0,0,0] op_sel_hi:[0,1,1]
    v_pk_add_f32 v[90:91], v[64:65], v[86:87]
    v_pk_add_f32 v[92:93], v[66:67], v[88:89]
    v_exp_f32 v94, v90
    v_exp_f32 v95, v91
    v_exp_f32 v96, v92
    v_exp_f32 v97, v93
    v_pk_fma_f32 v[98:99], v[98:99], v[94:95], v[98:99]
    v_pk_fma_f32 v[100:101], v[100:101], v[96:97], v[100:101]
    v_pk_fma_f32 v[98:99], v[90:91], v[102:103], v[98:99]
    v_pk_fma_f32 v[100:101], v[92:93], v[104:105], v[100:101]
    v_pk_fma_f32 v[102:103], v[102:103], v[94:95], v[102:103]
    v_pk_fma_f32 v[104:105], v[104:105], v[96:97], v[104:105]
L_blk_f_1_a:
    s_bitcmp1_b32 s64, 3
    s_cbranch_scc1 L_blk_f_1_f1
    v_pk_fma_f32 v[86:87], v[74:75], v[124:125], v[78:79] op_sel:[1,0,0] op_sel_hi:[1,1,1]
    v_pk_fma_f32 v[88:89], v[74:75], v[126:127], v[80:81] op_sel:[1,0,0] op_sel_hi:[1,1,1]
    v_pk_add_f32 v[90:91], v[68:69], v[86:87]
    v_pk_add_f32 v[92:93], v[70:71], v[88:89]
    v_exp_f32 v94, v90
    v_exp_f32 v95, v91
    v_exp_f32 v96, v92
    v_exp_f32 v97, v93
    v_pk_fma_f32 v[98:99], v[98:99], v[94:95], v[98:99]
    v_pk_fma_f32 v[100:101], v[100:101], v[96:97], v[100:101]
    v_pk_fma_f32 v[98:99], v[90:91], v[102:103], v[98:99]
    v_pk_fma_f32 v[100:101], v[92:93], v[104:105], v[100:101]
    v_pk_fma_f32 v[102:103], v[102:103], v[94:95], v[102:103]
    v_pk_fma_f32 v[104:105], v[104:105], v[96:97], v[104:105]
    s_branch L_back_f_1
L_blk_f_1_f0:
    s_add_u32 s88, s66, 2
    s_cmp_eq_u32 s88, s67
    s_cbranch_scc1 L_fin_f
    v_readlane_b32 s89, v118, s88
    v_rcp_f32 v94, v102
    v_rcp_f32 v95, v103
    v_rcp_f32 v96, v104
    v_rcp_f32 v97, v105
    s_and_b32 s90, s89, 0xffff
    s_lshr_b32 s91, s89, 16
    v_add_u32 v112, s90, v83
    ds_read2st64_b32 v[78:79], v112 offset0:0 offset1:1
    ds_read2st64_b32 v[80:81], v112 offset0:2 offset1:3
    v_max3_f32 v108, v108, v102, v103
    v_max3_f32 v108, v108, v104, v105
    v_pk_mul_f32 v[90:91], v[98:99], v[94:95]
    v_pk_mul_f32 v[92:93], v[100:101], v[96:97]
    v_pk_fma_f32 v[106:107], v[90:91], 0, v[106:107] op_sel_hi:[1,0,1]
    v_pk_fma_f32 v[106:107], v[92:93], 0, v[106:107] op_sel_hi:[1,0,1]
    v_cvt_pk_bf16_f32 v94, v90, v91
    v_cvt_pk_bf16_f32 v95, v92, v93
    ds_write_b64 v113, v[94:95]
    v_xor_b32 v113, s91, v84
    s_waitcnt lgkmcnt(1)
    v_pk_fma_f32 v[86:87], v[74:75], v[124:125], v[78:79] op_sel:[0,0,0] op_sel_hi:[0,1,1]
    v_pk_fma_f32 v[88:89], v[74:75], v[126:127], v[80:81] op_sel:[0,0,0] op_sel_hi:[0,1,1]
    v_pk_add_f32 v[98:99], v[64:65], v[86:87]
    v_pk_add_f32 v[100:101], v[66:67], v[88:89]
    v_exp_f32 v94, v98
    v_exp_f32 v95, v99
    v_exp_f32 v96, v100
    v_exp_f32 v97, v101
    v_pk_add_f32 v[102:103], v[94:95], 1.0 op_sel_hi:[1,0]
    v_pk_add_f32 v[104:105], v[96:97], 1.0 op_sel_hi:[1,0]
    s_branch L_blk_f_1_a
L_blk_f_1_f1:
    s_add_u32 s88, s66, 3
    s_cmp_eq_u32 s88, s67
    s_cbranch_scc1 L_fin_f
    v_readlane_b32 s89, v118, s88
    v_rcp_f32 v94, v102
    v_rcp_f32 v95, v103
    v_rcp_f32 v96, v104
    v_rcp_f32 v97, v105
    s_and_b32 s90, s89, 0xffff
    s_lshr_b32 s91, s89, 16
    v_add_u32 v112, s90, v83
    ds_read2st64_b32 v[78:79], v112 offset0:0 offset1:1
    ds_read2st64_b32 v[80:81], v112 offset0:2 offset1:3
    v_max3_f32 v108, v108, v102, v103
    v_max3_f32 v108, v108, v104, v105
    v_pk_mul_f32 v[90:91], v[98:99], v[94:95]
    v_pk_mul_f32 v[92:93], v[100:101], v[96:97]
    v_pk_fma_f32 v[106:107], v[90:91], 0, v[106:107] op_sel_hi:[1,0,1]
    v_pk_fma_f32 v[106:107], v[92:93], 0, v[106:107] op_sel_hi:[1,0,1]
    v_cvt_pk_bf16_f32 v94, v90, v91
    v_cvt_pk_bf16_f32 v95, v92, v93
    ds_write_b64 v113, v[94:95]
    v_xor_b32 v113, s91, v84
    s_waitcnt lgkmcnt(1)
    v_pk_fma_f32 v[86:87], v[74:75], v[124:125], v[78:79] op_sel:[1,0,0] op_sel_hi:[1,1,1]
    v_pk_fma_f32 v[88:89], v[74:75], v[126:127], v[80:81] op_sel:[1,0,0] op_sel_hi:[1,1,1]
    v_pk_add_f32 v[98:99], v[68:69], v[86:87]
    v_pk_add_f32 v[100:101], v[70:71], v[88:89]
    v_exp_f32 v94, v98
    v_exp_f32 v95, v99
    v_exp_f32 v96, v100
    v_exp_f32 v97, v101
    v_pk_add_f32 v[102:103], v[94:95], 1.0 op_sel_hi:[1,0]
    v_pk_add_f32 v[104:105], v[96:97], 1.0 op_sel_hi:[1,0]
    s_branch L_back_f_1
L_blk_f_2:
    s_waitcnt vmcnt(11)
    s_cmp_eq_u32 s66, s39
    s_cbranch_scc1 L_blk_f_2_w
    s_waitcnt vmcnt(3)
L_blk_f_2_w:
    ds_read_u16_d16_hi v64, v82 offset:33792
    ds_read_u16_d16_hi v65, v82 offset:33920
    ds_read_u16_d16_hi v66, v82 offset:34048
    ds_read_u16_d16_hi v67, v82 offset:34176
    ds_read_u16_d16_hi v68, v82 offset:34304
    ds_read_u16_d16_hi v69, v82 offset:34432
    ds_read_u16_d16_hi v70, v82 offset:34560
    ds_read_u16_d16_hi v71, v82 offset:34688
    ds_read_b64 v[74:75], v117 offset:24
    ds_read_u16 v76, v116 offset:28
    s_bitcmp1_b32 s64, 4
    s_cbranch_scc1 L_blk_f_2_f0
    v_pk_fma_f32 v[86:87], v[72:73], v[124:125], v[78:79] op_sel:[0,0,0] op_sel_hi:[0,1,1]
    v_pk_fma_f32 v[88:89], v[72:73], v[126:127], v[80:81] op_sel:[0,0,0] op_sel_hi:[0,1,1]
    v_pk_add_f32 v[90:91], v[56:57], v[86:87]
    v_pk_add_f32 v[92:93], v[58:59], v[88:89]
    v_exp_f32 v94, v90
    v_exp_f32 v95, v91
    v_exp_f32 v96, v92
    v_exp_f32 v97, v93
    v_pk_fma_f32 v[98:99], v[98:99], v[94:95], v[98:99]
    v_pk_fma_f32 v[100:101], v[100:101], v[96:97], v[100:101]
    v_pk_fma_f32 v[98:99], v[90:91], v[102:103], v[98:99]
    v_pk_fma_f32 v[100:101], v[92:93], v[104:105], v[100:101]
    v_pk_fma_f32 v[102:103], v[102:103], v[94:95], v[102:103]
    v_pk_fma_f32 v[104:105], v[104:105], v[96:97], v[104:105]
L_blk_f_2_a:
    s_bitcmp1_b32 s64, 5
    s_cbranch_scc1 L_blk_f_2_f1
    v_pk_fma_f32 v[86:87], v[72:73], v[124:125], v[78:79] op_sel:[1,0,0] op_sel_hi:[1,1,1]
    v_pk_fma_f32 v[88:89], v[72:73], v[126:127], v[80:81] op_sel:[1,0,0] op_sel_hi:[1,1,1]
    v_pk_add_f32 v[90:91], v[60:61], v[86:87]
    v_pk_add_f32 v[92:93], v[62:63], v[88:89]
    v_exp_f32 v94, v90
    v_exp_f32 v95, v91
    v_exp_f32 v96, v92
    v_exp_f32 v97, v93
    v_pk_fma_f32 v[98:99], v[98:99], v[94:95], v[98:99]
    v_pk_fma_f32 v[100:101], v[100:101], v[96:97], v[100:101]
    v_pk_fma_f32 v[98:99], v[90:91], v[102:103], v[98:99]
    v_pk_fma_f32 v[100:101], v[92:93], v[104:105], v[100:101]
    v_pk_fma_f32 v[102:103], v[102:103], v[94:95], v[102:103]
    v_pk_fma_f32 v[104:105], v[104:105], v[96:97], v[104:105]
    s_branch L_back_f_2
L_blk_f_2_f0:
    s_add_u32 s88, s66, 4
    s_cmp_eq_u32 s88, s67
    s_cbranch_scc1 L_fin_f
    v_readlane_b32 s89, v118, s88
    v_rcp_f32 v94, v102
    v_rcp_f32 v95, v103
    v_rcp_f32 v96, v104
    v_rcp_f32 v97, v105
    s_and_b32 s90, s89, 0xffff
    s_lshr_b32 s91, s89, 16
    v_add_u32 v112, s90, v83
    ds_read2st64_b32 v[78:79], v112 offset0:0 offset1:1
    ds_read2st64_b32 v[80:81], v112 offset0:2 offset1:3
    v_max3_f32 v108, v108, v102, v103
    v_max3_f32 v108, v108, v104, v105
    v_pk_mul_f32 v[90:91], v[98:99], v[94:95]
    v_pk_mul_f32 v[92:93], v[100:101], v[96:97]
    v_pk_fma_f32 v[106:107], v[90:91], 0, v[106:107] op_sel_hi:[1,0,1]
    v_pk_fma_f32 v[106:107], v[92:93], 0, v[106:107] op_sel_hi:[1,0,1]
    v_cvt_pk_bf16_f32 v94, v90, v91
    v_cvt_pk_bf16_f32 v95, v92, v93
    ds_write_b64 v113, v[94:95]
    v_xor_b32 v113, s91, v84
    s_waitcnt lgkmcnt(1)
    v_pk_fma_f32 v[86:87], v[72:73], v[124:125], v[78:79] op_sel:[0,0,0] op_sel_hi:[0,1,1]
    v_pk_fma_f32 v[88:89], v[72:73], v[126:127], v[80:81] op_sel:[0,0,0] op_sel_hi:[0,1,1]
    v_pk_add_f32 v[98:99], v[56:57], v[86:87]
    v_pk_add_f32 v[100:101], v[58:59], v[88:89]
    v_exp_f32 v94, v98
    v_exp_f32 v95, v99
    v_exp_f32 v96, v100
    v_exp_f32 v97, v101
    v_pk_add_f32 v[102:103], v[94:95], 1.0 op_sel_hi:[1,0]
    v_pk_add_f32 v[104:105], v[96:97], 1.0 op_sel_hi:[1,0]
    s_branch L_blk_f_2_a
L_blk_f_2_f1:
    s_add_u32 s88, s66, 5
    s_cmp_eq_u32 s88, s67
    s_cbranch_scc1 L_fin_f
    v_readlane_b32 s89, v118, s88
    v_rcp_f32 v94, v102
    v_rcp_f32 v95, v103
    v_rcp_f32 v96, v104
    v_rcp_f32 v97, v105
    s_and_b32 s90, s89, 0xffff
    s_lshr_b32 s91, s89, 16
    v_add_u32 v112, s90, v83
    ds_read2st64_b32 v[78:79], v112 offset0:0 offset1:1
    ds_read2st64_b32 v[80:81], v112 offset0:2 offset1:3
    v_max3_f32 v108, v108, v102, v103
    v_max3_f32 v108, v108, v104, v105
    v_pk_mul_f32 v[90:91], v[98:99], v[94:95]
    v_pk_mul_f32 v[92:93], v[100:101], v[96:97]
    v_pk_fma_f32 v[106:107], v[90:91], 0, v[106:107] op_sel_hi:[1,0,1]
    v_pk_fma_f32 v[106:107], v[92:93], 0, v[106:107] op_sel_hi:[1,0,1]
    v_cvt_pk_bf16_f32 v94, v90, v91
    v_cvt_pk_bf16_f32 v95, v92, v93
    ds_write_b64 v113, v[94:95]
    v_xor_b32 v113, s91, v84
    s_waitcnt lgkmcnt(1)
    v_pk_fma_f32 v[86:87], v[72:73], v[124:125], v[78:79] op_sel:[1,0,0] op_sel_hi:[1,1,1]
    v_pk_fma_f32 v[88:89], v[72:73], v[126:127], v[80:81] op_sel:[1,0,0] op_sel_hi:[1,1,1]
    v_pk_add_f32 v[98:99], v[60:61], v[86:87]
    v_pk_add_f32 v[100:101], v[62:63], v[88:89]
    v_exp_f32 v94, v98
    v_exp_f32 v95, v99
    v_exp_f32 v96, v100
    v_exp_f32 v97, v101
    v_pk_add_f32 v[102:103], v[94:95], 1.0 op_sel_hi:[1,0]
    v_pk_add_f32 v[104:105], v[96:97], 1.0 op_sel_hi:[1,0]
    s_branch L_back_f_2
L_blk_f_3:
    s_waitcnt vmcnt(11)
    s_cmp_eq_u32 s66, s39
    s_cbranch_scc1 L_blk_f_3_w
    s_waitcnt vmcnt(3)
L_blk_f_3_w:
    ds_read_u16_d16_hi v56, v82 offset:0
    ds_read_u16_d16_hi v57, v82 offset:128
    ds_read_u16_d16_hi v58, v82 offset:256
    ds_read_u16_d16_hi v59, v82 offset:384
    ds_read_u16_d16_hi v60, v82 offset:512
    ds_read_u16_d16_hi v61, v82 offset:640
    ds_read_u16_d16_hi v62, v82 offset:768
    ds_read_u16_d16_hi v63, v82 offset:896
    ds_read_b64 v[72:73], v117 offset:32
    ds_read_u16 v76, v116 offset:32
    s_bitcmp1_b32 s64, 6
    s_cbranch_scc1 L_blk_f_3_f0
    v_pk_fma_f32 v[86:87], v[74:75], v[124:125], v[78:79] op_sel:[0,0,0] op_sel_hi:[0,1,1]
    v_pk_fma_f32 v[88:89], v[74:75], v[126:127], v[80:81] op_sel:[0,0,0] op_sel_hi:[0,1,1]
    v_pk_add_f32 v[90:91], v[64:65], v[86:87]
    v_pk_add_f32 v[92:93], v[66:67], v[88:89]
    v_exp_f32 v94, v90
    v_exp_f32 v95, v91
    v_exp_f32 v96, v92
    v_exp_f32 v97, v93
    v_pk_fma_f32 v[98:99], v[98:99], v[94:95], v[98:99]
    v_pk_fma_f32 v[100:101], v[100:101], v[96:97], v[100:101]
    v_pk_fma_f32 v[98:99], v[90:91], v[102:103], v[98:99]
    v_pk_fma_f32 v[100:101], v[92:93], v[104:105], v[100:101]
    v_pk_fma_f32 v[102:103], v[102:103], v[94:95], v[102:103]
    v_pk_fma_f32 v[104:105], v[104:105], v[96:97], v[104:105]
L_blk_f_3_a:
    s_bitcmp1_b32 s64, 7
    s_cbranch_scc1 L_blk_f_3_f1
    v_pk_fma_f32 v[86:87], v[74:75], v[124:125], v[78:79] op_sel:[1,0,0] op_sel_hi:[1,1,1]
    v_pk_fma_f32 v[88:89], v[74:75], v[126:127], v[80:81] op_sel:[1,0,0] op_sel_hi:[1,1,1]
    v_pk_add_f32 v[90:91], v[68:69], v[86:87]
    v_pk_add_f32 v[92:93], v[70:71], v[88:89]
    v_exp_f32 v94, v90
    v_exp_f32 v95, v91
    v_exp_f32 v96, v92
    v_exp_f32 v97, v93
    v_pk_fma_f32 v[98:99], v[98:99], v[94:95], v[98:99]
    v_pk_fma_f32 v[100:101], v[100:101], v[96:97], v[100:101]
    v_pk_fma_f32 v[98:99], v[90:91], v[102:103], v[98:99]
    v_pk_fma_f32 v[100:101], v[92:93], v[104:105], v[100:101]
    v_pk_fma_f32 v[102:103], v[102:103], v[94:95], v[102:103]
    v_pk_fma_f32 v[104:105], v[104:105], v[96:97], v[104:105]
    s_branch L_back_f_3
L_blk_f_3_f0:
    s_add_u32 s88, s66, 6
    s_cmp_eq_u32 s88, s67
    s_cbranch_scc1 L_fin_f
    v_readlane_b32 s89, v118, s88
    v_rcp_f32 v94, v102
    v_rcp_f32 v95, v103
    v_rcp_f32 v96, v104
    v_rcp_f32 v97, v105
    s_and_b32 s90, s89, 0xffff
    s_lshr_b32 s91, s89, 16
    v_add_u32 v112, s90, v83
    ds_read2st64_b32 v[78:79], v112 offset0:0 offset1:1
    ds_read2st64_b32 v[80:81], v112 offset0:2 offset1:3
    v_max3_f32 v108, v108, v102, v103
    v_max3_f32 v108, v108, v104, v105
    v_pk_mul_f32 v[90:91], v[98:99], v[94:95]
    v_pk_mul_f32 v[92:93], v[100:101], v[96:97]
    v_pk_fma_f32 v[106:107], v[90:91], 0, v[106:107] op_sel_hi:[1,0,1]
    v_pk_fma_f32 v[106:107], v[92:93], 0, v[106:107] op_sel_hi:[1,0,1]
    v_cvt_pk_bf16_f32 v94, v90, v91
    v_cvt_pk_bf16_f32 v95, v92, v93
    ds_write_b64 v113, v[94:95]
    v_xor_b32 v113, s91, v84
    s_waitcnt lgkmcnt(1)
    v_pk_fma_f32 v[86:87], v[74:75], v[124:125], v[78:79] op_sel:[0,0,0] op_sel_hi:[0,1,1]
    v_pk_fma_f32 v[88:89], v[74:75], v[126:127], v[80:81] op_sel:[0,0,0] op_sel_hi:[0,1,1]
    v_pk_add_f32 v[98:99], v[64:65], v[86:87]
    v_pk_add_f32 v[100:101], v[66:67], v[88:89]
    v_exp_f32 v94, v98
    v_exp_f32 v95, v99
    v_exp_f32 v96, v100
    v_exp_f32 v97, v101
    v_pk_add_f32 v[102:103], v[94:95], 1.0 op_sel_hi:[1,0]
    v_pk_add_f32 v[104:105], v[96:97], 1.0 op_sel_hi:[1,0]
    s_branch L_blk_f_3_a
L_blk_f_3_f1:
    s_add_u32 s88, s66, 7
    s_cmp_eq_u32 s88, s67
    s_cbranch_scc1 L_fin_f
    v_readlane_b32 s89, v118, s88
    v_rcp_f32 v94, v102
    v_rcp_f32 v95, v103
    v_rcp_f32 v96, v104
    v_rcp_f32 v97, v105
    s_and_b32 s90, s89, 0xffff
    s_lshr_b32 s91, s89, 16
    v_add_u32 v112, s90, v83
    ds_read2st64_b32 v[78:79], v112 offset0:0 offset1:1
    ds_read2st64_b32 v[80:81], v112 offset0:2 offset1:3
    v_max3_f32 v108, v108, v102, v103
    v_max3_f32 v108, v108, v104, v105
    v_pk_mul_f32 v[90:91], v[98:99], v[94:95]
    v_pk_mul_f32 v[92:93], v[100:101], v[96:97]
    v_pk_fma_f32 v[106:107], v[90:91], 0, v[106:107] op_sel_hi:[1,0,1]
    v_pk_fma_f32 v[106:107], v[92:93], 0, v[106:107] op_sel_hi:[1,0,1]
    v_cvt_pk_bf16_f32 v94, v90, v91
    v_cvt_pk_bf16_f32 v95, v92, v93
    ds_write_b64 v113, v[94:95]
    v_xor_b32 v113, s91, v84
    s_waitcnt lgkmcnt(1)
    v_pk_fma_f32 v[86:87], v[74:75], v[124:125], v[78:79] op_sel:[1,0,0] op_sel_hi:[1,1,1]
    v_pk_fma_f32 v[88:89], v[74:75], v[126:127], v[80:81] op_sel:[1,0,0] op_sel_hi:[1,1,1]
    v_pk_add_f32 v[98:99], v[68:69], v[86:87]
    v_pk_add_f32 v[100:101], v[70:71], v[88:89]
    v_exp_f32 v94, v98
    v_exp_f32 v95, v99
    v_exp_f32 v96, v100
    v_exp_f32 v97, v101
    v_pk_add_f32 v[102:103], v[94:95], 1.0 op_sel_hi:[1,0]
    v_pk_add_f32 v[104:105], v[96:97], 1.0 op_sel_hi:[1,0]
    s_branch L_back_f_3
L_fin_f:
    v_rcp_f32 v94, v102
    v_rcp_f32 v95, v103
    v_rcp_f32 v96, v104
    v_rcp_f32 v97, v105
    v_max3_f32 v108, v108, v102, v103
    v_max3_f32 v108, v108, v104, v105
    v_pk_mul_f32 v[90:91], v[98:99], v[94:95]
    v_pk_mul_f32 v[92:93], v[100:101], v[96:97]
    v_pk_fma_f32 v[106:107], v[90:91], 0, v[106:107] op_sel_hi:[1,0,1]
    v_pk_fma_f32 v[106:107], v[92:93], 0, v[106:107] op_sel_hi:[1,0,1]
    s_cmp_eq_u32 s48, 0
    s_cbranch_scc1 L_noside_f
    s_lshl_b32 s88, s3, 9
    s_add_u32 s88, s88, 173568
    v_xor_b32 v112, s88, v84
    s_mov_b32 s90, 0
L_side_f:
    ds_read_b64 v[94:95], v112
    s_add_u32 s90, s90, 1
    s_waitcnt lgkmcnt(0)
    v_cmp_eq_u64 vcc, -1, v[94:95]
    s_cmp_gt_u32 s90, 40000
    s_cbranch_scc1 L_side_go_f
    s_cbranch_vccnz L_side_f
L_side_go_f:
    v_lshlrev_b32 v86, 16, v94
    v_and_b32 v87, 0xffff0000, v94
    v_lshlrev_b32 v88, 16, v95
    v_and_b32 v89, 0xffff0000, v95
    v_pk_add_f32 v[90:91], v[90:91], v[86:87]
    v_pk_add_f32 v[92:93], v[92:93], v[88:89]
L_noside_f:
    v_cvt_pk_bf16_f32 v94, v90, v91
    v_cvt_pk_bf16_f32 v95, v92, v93
    ds_write_b64 v113, v[94:95]
    s_cmp_eq_u32 s39, -1
    s_cbranch_scc0 L_main_done
    s_lshl_b32 s88, s3, 14
    s_add_u32 s88, s88, 7348224
    s_add_u32 s89, s88, 4096
    v_lshlrev_b32 v120, 4, v1
    buffer_load_dwordx4 v[24:27], v120, s[16:19], s88 offen offset:0 sc1
    buffer_load_dwordx4 v[28:31], v120, s[16:19], s88 offen offset:1024 sc1
    buffer_load_dwordx4 v[32:35], v120, s[16:19], s88 offen offset:2048 sc1
    buffer_load_dwordx4 v[36:39], v120, s[16:19], s88 offen offset:3072 sc1
    buffer_load_dwordx4 v[40:43], v120, s[16:19], s89 offen offset:0 sc1
    buffer_load_dwordx4 v[44:47], v120, s[16:19], s89 offen offset:1024 sc1
    buffer_load_dwordx4 v[48:51], v120, s[16:19], s89 offen offset:2048 sc1
    buffer_load_dwordx4 v[52:55], v120, s[16:19], s89 offen offset:3072 sc1
    s_branch L_main_done
L_main_done:
    s_setprio 0
    v_add_f32 v106, v106, v107
    v_mov_b32 v120, 2071986176
    v_cmp_u_f32 vcc, v106, v106
    v_cmp_nle_f32 s[40:41], v108, v120
    s_nop 1
    s_or_b64 vcc, vcc, s[40:41]
    s_cbranch_scc0 L_after
    v_mov_b32 v120, 161028
    v_mov_b32 v121, 1
    ds_write_b32 v120, v121
L_after:
    v_xor_b32 v119, 0x80, v6
    v_and_b32 v120, 8, v1
    v_subrev_u32 v119, 4092, v119
    v_cmp_eq_u32 vcc, 0, v120
    s_nop 1
    v_cndmask_b32 v119, v119, v6, vcc
    s_waitcnt vmcnt(0)
    s_waitcnt lgkmcnt(0)
    s_barrier
    v_mov_b32 v120, 161028
    ds_read_b32 v121, v120
    ds_read_b128 v[56:59], v2 offset:0
    ds_read_b128 v[60:63], v3 offset:0
    ds_read_b128 v[64:67], v4 offset:0
    ds_read_b128 v[68:71], v5 offset:0
    ds_read_b128 v[72:75], v2 offset:256
    ds_read_b128 v[76:79], v3 offset:256
    ds_read_b128 v[80:83], v4 offset:256
    ds_read_b128 v[84:87], v5 offset:256
    ds_read_b128 v[88:91], v2 offset:8192
    ds_read_b128 v[92:95], v3 offset:8192
    ds_read_b128 v[96:99], v4 offset:8192
    ds_read_b128 v[100:103], v5 offset:8192
    s_cmp_eq_u32 s79, 0
    s_cbranch_scc0 L_slow_next
    s_waitcnt lgkmcnt(12)
    v_readfirstlane_b32 s88, v121
    s_nop 1
    s_cmp_eq_u32 s88, 0
    s_cbranch_scc0 L_redo
L_final:
    s_waitcnt lgkmcnt(11)
    v_mfma_f32_16x16x32_bf16 v[12:15], v[24:27], v[56:59], v[12:15]
    ds_read_b128 v[56:59], v2 offset:8448
    s_waitcnt lgkmcnt(11)
    v_mfma_f32_16x16x32_bf16 v[12:15], v[28:31], v[60:63], v[12:15]
    ds_read_b128 v[60:63], v3 offset:8448
    s_waitcnt lgkmcnt(11)
    v_mfma_f32_16x16x32_bf16 v[12:15], v[32:35], v[64:67], v[12:15]
    ds_read_b128 v[64:67], v4 offset:8448
    s_waitcnt lgkmcnt(11)
    v_mfma_f32_16x16x32_bf16 v[12:15], v[36:39], v[68:71], v[12:15]
    ds_read_b128 v[68:71], v5 offset:8448
    s_waitcnt lgkmcnt(11)
    v_mfma_f32_16x16x32_bf16 v[12:15], v[40:43], v[72:75], v[12:15]
    ds_read_b128 v[72:75], v2 offset:16384
    s_waitcnt lgkmcnt(11)
    v_mfma_f32_16x16x32_bf16 v[12:15], v[44:47], v[76:79], v[12:15]
    ds_read_b128 v[76:79], v3 offset:16384
    s_waitcnt lgkmcnt(11)
    v_mfma_f32_16x16x32_bf16 v[12:15], v[48:51], v[80:83], v[12:15]
    ds_read_b128 v[80:83], v4 offset:16384
    s_waitcnt lgkmcnt(11)
    v_mfma_f32_16x16x32_bf16 v[12:15], v[52:55], v[84:87], v[12:15]
    ds_read_b128 v[84:87], v5 offset:16384
    s_waitcnt lgkmcnt(11)
    v_mfma_f32_16x16x32_bf16 v[16:19], v[24:27], v[88:91], v[16:19]
    ds_read_b128 v[88:91], v2 offset:16640
    s_waitcnt lgkmcnt(11)
    v_mfma_f32_16x16x32_bf16 v[16:19], v[28:31], v[92:95], v[16:19]
    ds_read_b128 v[92:95], v3 offset:16640
    s_nop 0
    v_exp_f32 v104, v12
    v_exp_f32 v105, v13
    v_exp_f32 v106, v14
    v_exp_f32 v107, v15
    s_waitcnt lgkmcnt(11)
    v_mfma_f32_16x16x32_bf16 v[16:19], v[32:35], v[96:99], v[16:19]
    ds_read_b128 v[96:99], v4 offset:16640
    v_add_f32 v104, 1.0, v104
    v_add_f32 v105, 1.0, v105
    v_add_f32 v106, 1.0, v106
    v_add_f32 v107, 1.0, v107
    s_waitcnt lgkmcnt(11)
    v_mfma_f32_16x16x32_bf16 v[16:19], v[36:39], v[100:103], v[16:19]
    ds_read_b128 v[100:103], v5 offset:16640
    v_rcp_f32 v104, v104
    v_rcp_f32 v105, v105
    v_rcp_f32 v106, v106
    v_rcp_f32 v107, v107
    s_waitcnt lgkmcnt(11)
    v_mfma_f32_16x16x32_bf16 v[16:19], v[40:43], v[56:59], v[16:19]
    v_mul_f32 v12, s60, v12
    v_mul_f32 v13, s60, v13
    v_mul_f32 v14, s60, v14
    v_mul_f32 v15, s60, v15
    s_waitcnt lgkmcnt(10)
    v_mfma_f32_16x16x32_bf16 v[16:19], v[44:47], v[60:63], v[16:19]
    v_mul_f32 v12, v12, v104
    v_mul_f32 v13, v13, v105
    v_mul_f32 v14, v14, v106
    v_mul_f32 v15, v15, v107
    s_waitcnt lgkmcnt(9)
    v_mfma_f32_16x16x32_bf16 v[16:19], v[48:51], v[64:67], v[16:19]
    v_cvt_pk_bf16_f32 v104, v12, v13
    v_cvt_pk_bf16_f32 v105, v14, v15
    ds_write_b64 v6, v[104:105] offset:0
    s_waitcnt lgkmcnt(9)
    v_mfma_f32_16x16x32_bf16 v[16:19], v[52:55], v[68:71], v[16:19]
    s_waitcnt lgkmcnt(8)
    v_mfma_f32_16x16x32_bf16 v[20:23], v[24:27], v[72:75], v[20:23]
    s_waitcnt lgkmcnt(7)
    v_mfma_f32_16x16x32_bf16 v[20:23], v[28:31], v[76:79], v[20:23]
    s_nop 3
    v_exp_f32 v108, v16
    v_exp_f32 v109, v17
    v_exp_f32 v110, v18
    v_exp_f32 v111, v19
    s_waitcnt lgkmcnt(6)
    v_mfma_f32_16x16x32_bf16 v[20:23], v[32:35], v[80:83], v[20:23]
    v_add_f32 v108, 1.0, v108
    v_add_f32 v109, 1.0, v109
    v_add_f32 v110, 1.0, v110
    v_add_f32 v111, 1.0, v111
    s_waitcnt lgkmcnt(5)
    v_mfma_f32_16x16x32_bf16 v[20:23], v[36:39], v[84:87], v[20:23]
    v_rcp_f32 v108, v108
    v_rcp_f32 v109, v109
    v_rcp_f32 v110, v110
    v_rcp_f32 v111, v111
    s_waitcnt lgkmcnt(4)
    v_mfma_f32_16x16x32_bf16 v[20:23], v[40:43], v[88:91], v[20:23]
    v_mul_f32 v16, s60, v16
    v_mul_f32 v17, s60, v17
    v_mul_f32 v18, s60, v18
    v_mul_f32 v19, s60, v19
    s_waitcnt lgkmcnt(3)
    v_mfma_f32_16x16x32_bf16 v[20:23], v[44:47], v[92:95], v[20:23]
    v_mul_f32 v16, v16, v108
    v_mul_f32 v17, v17, v109
    v_mul_f32 v18, v18, v110
    v_mul_f32 v19, v19, v111
    s_waitcnt lgkmcnt(2)
    v_mfma_f32_16x16x32_bf16 v[20:23], v[48:51], v[96:99], v[20:23]
    v_cvt_pk_bf16_f32 v108, v16, v17
    v_cvt_pk_bf16_f32 v109, v18, v19
    ds_write_b64 v6, v[108:109] offset:8192
    s_waitcnt lgkmcnt(2)
    v_mfma_f32_16x16x32_bf16 v[20:23], v[52:55], v[100:103], v[20:23]
    s_waitcnt lgkmcnt(0)
    s_barrier
    ds_read_b128 v[32:35], v9
    s_nop 4
    v_mov_b32_dpp v20, v22 row_shr:8 row_mask:0xf bank_mask:0xc
    v_mov_b32_dpp v21, v23 row_shr:8 row_mask:0xf bank_mask:0xc
    v_exp_f32 v112, v20
    v_exp_f32 v113, v21
    v_pk_mul_f32 v[20:21], v[20:21], s[60:61] op_sel_hi:[1,0]
    v_pk_add_f32 v[112:113], v[112:113], 1.0 op_sel_hi:[1,0]
    v_rcp_f32 v112, v112
    v_rcp_f32 v113, v113
    s_nop 0
    v_pk_mul_f32 v[20:21], v[20:21], v[112:113]
    v_cvt_pk_bf16_f32 v112, v20, v21
    ds_write_b32 v119, v112 offset:16384
    s_waitcnt lgkmcnt(1)
    buffer_store_dwordx4 v[32:35], v7, s[24:27], 0 offen sc1
    s_waitcnt lgkmcnt(0)
    s_barrier
    s_cmp_lt_u32 s3, 4
    s_cbranch_scc0 L_stored
    ds_read_b128 v[36:39], v9 offset:16384
    s_waitcnt lgkmcnt(0)
    buffer_store_dwordx4 v[36:39], v8, s[24:27], 0 offen sc1
L_stored:
L_end:
    s_endpgm
L_gen1:
    s_mov_b32 s57, 1
    s_mov_b32 s66, 0
    s_mov_b32 s67, 0
    s_branch L_gen1_back
L_clear:
    v_mov_b64 v[56:57], 0
    v_mov_b64 v[58:59], 0
    v_add_u32 v60, 65536, v9
    ds_write_b128 v60, v[56:59]
    s_cmp_lt_u32 s3, 4
    s_cbranch_scc0 L_zagg_26
    ds_write_b128 v60, v[56:59] offset:16384
L_zagg_26:
    s_cmp_eq_u32 s79, 2
    s_cbranch_scc0 L_clear2
    v_add_u32 v60, 4294878208, v60
    ds_write_b128 v60, v[56:59]
    s_cmp_lt_u32 s3, 4
    s_cbranch_scc0 L_zagg_27
    ds_write_b128 v60, v[56:59] offset:16384
L_zagg_27:
L_clear2:
    s_waitcnt lgkmcnt(0)
    s_barrier
    s_branch L_r_done
L_generic:
    s_waitcnt vmcnt(0) lgkmcnt(0)
    s_barrier
    s_mov_b32 s79, 2
    v_mov_b64 v[56:57], 0
    v_mov_b64 v[58:59], 0
    v_add_u32 v60, 65536, v9
    ds_write_b128 v60, v[56:59]
    s_cmp_lt_u32 s3, 4
    s_cbranch_scc0 L_zagg_28
    ds_write_b128 v60, v[56:59] offset:16384
L_zagg_28:
    s_cmp_eq_u32 s79, 2
    s_cbranch_scc0 L_gen2
    v_add_u32 v60, 4294878208, v60
    ds_write_b128 v60, v[56:59]
    s_cmp_lt_u32 s3, 4
    s_cbranch_scc0 L_zagg_29
    ds_write_b128 v60, v[56:59] offset:16384
L_zagg_29:
L_gen2:
    v_add_u32 v109, 160768, v83
    v_mov_b32 v115, 0
    ds_write_b32 v109, v115
    s_waitcnt lgkmcnt(0)
    s_barrier
L_round:
    s_lshl_b32 s88, s3, 11
    s_add_u32 s70, s88, 65536
    s_add_u32 s71, s88, 66560
    s_add_u32 s72, s88, 98304
    s_add_u32 s73, s88, 99328
    v_and_b32 v77, 31, v1
    v_lshlrev_b32 v77, 4, v77
    v_lshl_add_u32 v82, v1, 1, s70
    v_lshlrev_b32 v83, 2, v1
    v_lshlrev_b32 v84, 3, v1
    v_or_b32 v84, 131072, v84
    s_lshl_b32 s88, s75, 2
    s_lshl_b32 s89, s75, 5
    v_mov_b32 v48, 2147483648
    s_add_u32 s90, s88, 4
    s_add_u32 s91, s88, 8
    v_cmp_lt_i32 s[80:81], s88, v11
    s_add_u32 s88, s88, 12
    v_cmp_lt_i32 s[82:83], s90, v11
    v_cmp_lt_i32 s[84:85], s91, v11
    v_cmp_lt_i32 s[86:87], s88, v11
    s_cmp_gt_u32 s76, 1
    s_cselect_b64 s[82:83], s[82:83], 0
    s_cselect_b64 s[84:85], s[84:85], 0
    s_cselect_b64 s[86:87], s[86:87], 0
    s_cmp_eq_u64 s[84:85], 0
    s_cbranch_scc1 L_hp_30
    v_cndmask_b32 v42, v48, v10, s[84:85]
    buffer_load_dwordx2 v[28:29], v42, s[16:19], s89 offen offset:64 sc1
    v_cndmask_b32 v43, v48, v10, s[86:87]
    buffer_load_dwordx2 v[30:31], v43, s[16:19], s89 offen offset:96 sc1
L_hp_30:
    v_cndmask_b32 v40, v48, v10, s[80:81]
    buffer_load_dwordx2 v[24:25], v40, s[16:19], s89 offen offset:0 sc1
    v_cndmask_b32 v41, v48, v10, s[82:83]
    buffer_load_dwordx2 v[26:27], v41, s[16:19], s89 offen offset:32 sc1
    s_waitcnt vmcnt(0)
    s_mov_b32 s74, 0
L_clean_31:
    s_mov_b64 s[40:41], 0
    s_mov_b64 exec, s[80:81]
    v_xor_b32 v24, s29, v24
    v_xor_b32 v25, s31, v25
    v_lshrrev_b32 v40, 24, v24
    v_lshl_or_b32 v40, v25, 16, v40
    v_cmp_ne_u32 vcc, 0, v40
    s_or_b64 s[40:41], s[40:41], vcc
    s_mov_b64 exec, s[82:83]
    v_xor_b32 v26, s29, v26
    v_xor_b32 v27, s31, v27
    v_lshrrev_b32 v41, 24, v26
    v_lshl_or_b32 v41, v27, 16, v41
    v_cmp_ne_u32 vcc, 0, v41
    s_or_b64 s[40:41], s[40:41], vcc
    s_cmp_eq_u64 s[84:85], 0
    s_cbranch_scc1 L_hp_33
    s_mov_b64 exec, s[84:85]
    v_xor_b32 v28, s29, v28
    v_xor_b32 v29, s31, v29
    v_lshrrev_b32 v42, 24, v28
    v_lshl_or_b32 v42, v29, 16, v42
    v_cmp_ne_u32 vcc, 0, v42
    s_or_b64 s[40:41], s[40:41], vcc
    s_mov_b64 exec, s[86:87]
    v_xor_b32 v30, s29, v30
    v_xor_b32 v31, s31, v31
    v_lshrrev_b32 v43, 24, v30
    v_lshl_or_b32 v43, v31, 16, v43
    v_cmp_ne_u32 vcc, 0, v43
    s_or_b64 s[40:41], s[40:41], vcc
L_hp_33:
    s_mov_b64 exec, -1
    s_cmp_eq_u64 s[40:41], 0
    s_cbranch_scc1 L_cleanok_32
    s_add_u32 s74, s74, 1
    s_cmp_gt_u32 s74, 200000
    s_cbranch_scc1 L_cleanok_32
    s_lshl_b32 s88, s75, 2
    s_lshl_b32 s89, s75, 5
    v_mov_b32 v48, 2147483648
    s_add_u32 s90, s88, 4
    s_add_u32 s91, s88, 8
    v_cmp_lt_i32 s[80:81], s88, v11
    s_add_u32 s88, s88, 12
    v_cmp_lt_i32 s[82:83], s90, v11
    v_cmp_lt_i32 s[84:85], s91, v11
    v_cmp_lt_i32 s[86:87], s88, v11
    s_cmp_gt_u32 s76, 1
    s_cselect_b64 s[82:83], s[82:83], 0
    s_cselect_b64 s[84:85], s[84:85], 0
    s_cselect_b64 s[86:87], s[86:87], 0
    s_cmp_eq_u64 s[84:85], 0
    s_cbranch_scc1 L_hp_34
    v_cndmask_b32 v42, v48, v10, s[84:85]
    buffer_load_dwordx2 v[28:29], v42, s[16:19], s89 offen offset:64 sc1
    v_cndmask_b32 v43, v48, v10, s[86:87]
    buffer_load_dwordx2 v[30:31], v43, s[16:19], s89 offen offset:96 sc1
L_hp_34:
    v_cndmask_b32 v40, v48, v10, s[80:81]
    buffer_load_dwordx2 v[24:25], v40, s[16:19], s89 offen offset:0 sc1
    v_cndmask_b32 v41, v48, v10, s[82:83]
    buffer_load_dwordx2 v[26:27], v41, s[16:19], s89 offen offset:32 sc1
    s_waitcnt vmcnt(0)
    s_branch L_clean_31
L_cleanok_32:
    v_mov_b32 v48, 1
    s_mov_b32 s88, 160768
    s_mov_b64 exec, s[80:81]
    v_bfe_u32 v40, v24, 16, 6
    v_lshl_add_u32 v40, v40, 2, s88
    ds_add_rtn_u32 v44, v40, v48
    s_mov_b64 exec, s[82:83]
    v_bfe_u32 v41, v26, 16, 6
    v_lshl_add_u32 v41, v41, 2, s88
    ds_add_rtn_u32 v45, v41, v48
    s_cmp_eq_u64 s[84:85], 0
    s_cbranch_scc1 L_hp_35
    s_mov_b64 exec, s[84:85]
    v_bfe_u32 v42, v28, 16, 6
    v_lshl_add_u32 v42, v42, 2, s88
    ds_add_rtn_u32 v46, v42, v48
    s_mov_b64 exec, s[86:87]
    v_bfe_u32 v43, v30, 16, 6
    v_lshl_add_u32 v43, v43, 2, s88
    ds_add_rtn_u32 v47, v43, v48
L_hp_35:
    s_mov_b64 exec, -1
    s_waitcnt lgkmcnt(0)
    s_barrier
    s_mov_b32 s88, 160768
    v_lshl_add_u32 v51, v1, 2, s88
    v_mov_b32 v50, 161024
    ds_read_b32 v48, v51
    ds_read_b32 v50, v50
    s_waitcnt lgkmcnt(0)
    v_mov_b32 v49, v48
    v_readfirstlane_b32 s77, v50
    v_cmp_eq_u32 s[6:7], 0, v48
    v_subrev_u32 v48, 157824, v48
    v_add_u32_dpp v49, v49, v49 row_shr:1 row_mask:0xf bank_mask:0xf bound_ctrl:0
    s_nop 1
    v_add_u32_dpp v49, v49, v49 row_shr:2 row_mask:0xf bank_mask:0xf bound_ctrl:0
    s_nop 1
    v_add_u32_dpp v49, v49, v49 row_shr:4 row_mask:0xf bank_mask:0xf bound_ctrl:0
    s_nop 1
    v_add_u32_dpp v49, v49, v49 row_shr:8 row_mask:0xf bank_mask:0xf bound_ctrl:0
    s_nop 1
    v_add_u32_dpp v49, v49, v49 row_bcast:15 row_mask:0xa bank_mask:0xf
    s_nop 1
    v_add_u32_dpp v49, v49, v49 row_bcast:31 row_mask:0xc bank_mask:0xf
    s_nop 0
    v_readlane_b32 s74, v49, 63
    v_sub_u32 v49, v49, v48
    s_cmp_gt_u32 s74, 1024
    s_cbranch_scc1 L_narrow
L_lists_36:
    ds_bpermute_b32 v40, v40, v49
    ds_bpermute_b32 v41, v41, v49
    s_cmp_eq_u64 s[84:85], 0
    s_cbranch_scc1 L_hp_37
    ds_bpermute_b32 v42, v42, v49
    ds_bpermute_b32 v43, v43, v49
L_hp_37:
    s_add_u32 s88, s74, 1
    s_lshr_b32 s88, s88, 1
    s_mul_i32 s89, s88, s3
    s_add_u32 s90, s89, s88
    s_lshr_b32 s66, s89, 4
    s_lshr_b32 s90, s90, 4
    s_sub_u32 s68, s90, s66
    s_lshl_b32 s90, s90, 1
    s_cmp_lt_u32 s90, s74
    s_cselect_b32 s48, 1, 0
    s_min_u32 s90, s90, s74
    s_lshl_b32 s66, s66, 1
    s_sub_u32 s67, s90, s66
    s_mov_b32 s88, 4294803200
    s_mov_b32 s89, 4294489664
    s_waitcnt lgkmcnt(0)
    s_mov_b64 exec, s[80:81]
    v_add_u32 v44, v44, v40
    v_lshl_add_u32 v40, v44, 1, s88
    v_lshl_add_u32 v48, v44, 2, s89
    ds_write_b8_d16_hi v44, v24
    ds_write_b16 v40, v24
    ds_write_b32 v48, v25
    s_mov_b64 exec, s[82:83]
    v_add_u32 v45, v45, v41
    v_lshl_add_u32 v41, v45, 1, s88
    v_lshl_add_u32 v49, v45, 2, s89
    ds_write_b8_d16_hi v45, v26
    ds_write_b16 v41, v26
    ds_write_b32 v49, v27
    s_cmp_eq_u64 s[84:85], 0
    s_cbranch_scc1 L_hp_38
    s_mov_b64 exec, s[84:85]
    v_add_u32 v46, v46, v42
    v_lshl_add_u32 v42, v46, 1, s88
    v_lshl_add_u32 v48, v46, 2, s89
    ds_write_b8_d16_hi v46, v28
    ds_write_b16 v42, v28
    ds_write_b32 v48, v29
    s_mov_b64 exec, s[86:87]
    v_add_u32 v47, v47, v43
    v_lshl_add_u32 v43, v47, 1, s88
    v_lshl_add_u32 v49, v47, 2, s89
    ds_write_b8_d16_hi v47, v30
    ds_write_b16 v43, v30
    ds_write_b32 v49, v31
L_hp_38:
    s_mov_b64 exec, -1
    s_waitcnt lgkmcnt(0)
    s_barrier
    s_add_u32 s91, s66, 157823
    v_add_u32 v118, s91, v1
    s_lshl_b32 s88, s66, 1
    s_add_u32 s88, s88, 151552
    v_lshl_add_u32 v117, v1, 1, s88
    ds_read_u16 v51, v117
    ds_read_u8 v48, v118
    ds_read_u8 v50, v118 offset:1
    ds_read_u8 v49, v118 offset:2
    s_cmp_lt_u32 s3, 9
    s_mov_b32 s90, 160384
    s_cselect_b32 s90, 158880, s90
    s_mul_i32 s89, s3, 192
    s_add_u32 s89, s89, s90
    v_lshl_add_u32 v118, v1, 1, s89
    v_mov_b32 v52, 0xffff
    v_cmp_gt_i32 vcc, s67, v1
    s_mov_b32 exec_hi, 0
    ds_write_b16 v118, v52 offset:128
    s_mov_b64 exec, -1
    v_lshrrev_b32 v116, 5, v1
    v_lshl_add_u32 v116, v116, 1, s89
    s_lshl_b32 s88, s66, 2
    s_add_u32 s88, s88, 153664
    v_mov_b32 v117, s88
    s_waitcnt lgkmcnt(4)
    v_cndmask_b32 v51, v52, v51, vcc
    ds_write_b16 v118, v51
    ds_read_u16 v64, v116 offset:0
    ds_read_u16 v65, v116 offset:4
    ds_read_u16 v66, v116 offset:8
    ds_read_u16 v67, v116 offset:12
    ds_read_u16 v68, v116 offset:16
    s_waitcnt lgkmcnt(7)
    v_cmp_ne_u32 s[64:65], v50, v49
    v_cmp_eq_u32 vcc, v50, v48
    v_mul_u32_u24 v118, 1040, v50
    v_and_b32 v49, 15, v50
    v_lshlrev_b32 v49, 4, v49
    v_lshl_add_u32 v49, v50, 9, v49
    v_lshl_or_b32 v118, v49, 16, v118
    s_sub_u32 s88, s67, 1
    s_bitcmp0_b64 s[64:65], s88
    s_cselect_b32 s48, s48, 0
    s_bitset1_b64 s[64:65], s88
    v_readfirstlane_b32 s89, v118
    s_lshr_b32 s69, s65, 31
    s_lshl_b32 s69, s69, 24
    s_lshl_b64 s[64:65], s[64:65], 1
    s_and_b32 s90, vcc_lo, 1
    s_cmp_eq_u32 s66, 0
    s_cselect_b32 s90, 0, s90
    s_cmp_lt_u32 s79, 2
    s_cselect_b32 s90, s90, 0
    s_lshl_b32 s88, s3, 9
    s_add_u32 s88, s88, 173056
    s_lshr_b32 s91, s89, 16
    s_cmp_eq_u32 s90, 0
    s_cselect_b32 s45, s91, s88
    s_and_b32 s44, s89, 0xffff
    s_waitcnt lgkmcnt(0)
    v_mov_b32 v76, v64
    s_mov_b32 m0, s70
    s_nop 0
    buffer_load_dwordx4 v[76:77], s[20:23], 0 idxen offen sc1 lds
    v_mov_b32 v76, v65
    s_mov_b32 m0, s71
    s_nop 0
    buffer_load_dwordx4 v[76:77], s[20:23], 0 idxen offen sc1 lds
    v_mov_b32 v76, v66
    s_mov_b32 m0, s72
    s_nop 0
    buffer_load_dwordx4 v[76:77], s[20:23], 0 idxen offen sc1 lds
    v_mov_b32 v76, v67
    s_mov_b32 m0, s73
    s_nop 0
    buffer_load_dwordx4 v[76:77], s[20:23], 0 idxen offen sc1 lds
    v_mov_b32 v76, v68
    s_branch L_r_done
L_narrow:
    s_waitcnt lgkmcnt(0)
    s_barrier
    v_add_u32 v109, 160768, v83
    v_mov_b32 v115, 0
    ds_write_b32 v109, v115
    s_mov_b32 s76, 1
    s_waitcnt lgkmcnt(0)
    s_barrier
    s_branch L_round
L_empty:
    v_add_u32 v109, 160768, v83
    v_mov_b32 v115, 0
    ds_write_b32 v109, v115
    s_lshl_b32 s88, s3, 14
    s_add_u32 s88, s88, 7348224
    s_add_u32 s89, s88, 4096
    v_lshlrev_b32 v120, 4, v1
    buffer_load_dwordx4 v[24:27], v120, s[16:19], s88 offen offset:0 sc1
    buffer_load_dwordx4 v[28:31], v120, s[16:19], s88 offen offset:1024 sc1
    buffer_load_dwordx4 v[32:35], v120, s[16:19], s88 offen offset:2048 sc1
    buffer_load_dwordx4 v[36:39], v120, s[16:19], s88 offen offset:3072 sc1
    buffer_load_dwordx4 v[40:43], v120, s[16:19], s89 offen offset:0 sc1
    buffer_load_dwordx4 v[44:47], v120, s[16:19], s89 offen offset:1024 sc1
    buffer_load_dwordx4 v[48:51], v120, s[16:19], s89 offen offset:2048 sc1
    buffer_load_dwordx4 v[52:55], v120, s[16:19], s89 offen offset:3072 sc1
    s_branch L_after
L_slow_next:
    s_cmp_eq_u32 s79, 1
    s_cbranch_scc1 L_final
    s_waitcnt lgkmcnt(0)
    s_add_u32 s75, s75, s76
    s_mov_b32 s76, 4
    s_max_u32 s88, s77, 16
    s_lshl_b32 s89, s75, 2
    s_cmp_lt_u32 s89, s88
    s_cbranch_scc1 L_round
L_convert:
    v_lshl_add_u32 v82, v1, 1, s70
    v_lshlrev_b32 v83, 2, v1
    v_lshlrev_b32 v84, 3, v1
    v_or_b32 v84, 131072, v84
    s_add_u32 s90, s3, 0
    s_min_u32 s90, s90, 39
    s_lshl_b32 s90, s90, 9
    s_lshr_b32 s91, s90, 9
    s_cmp_lt_u32 s91, 20
    s_cselect_b32 s88, 128, 21
    s_add_u32 s91, s91, s88
    s_lshl_b32 s91, s91, 10
    v_add_u32 v120, s91, v83
    ds_read2st64_b32 v[56:57], v120 offset0:0 offset1:1
    ds_read2st64_b32 v[58:59], v120 offset0:2 offset1:3
    s_bfe_u32 s91, s90, 0x40009
    s_lshl_b32 s91, s91, 4
    s_or_b32 s91, s91, s90
    v_xor_b32 v68, s91, v84
    s_add_u32 s90, s3, 16
    s_min_u32 s90, s90, 39
    s_lshl_b32 s90, s90, 9
    s_lshr_b32 s91, s90, 9
    s_cmp_lt_u32 s91, 20
    s_cselect_b32 s88, 128, 21
    s_add_u32 s91, s91, s88
    s_lshl_b32 s91, s91, 10
    v_add_u32 v120, s91, v83
    ds_read2st64_b32 v[60:61], v120 offset0:0 offset1:1
    ds_read2st64_b32 v[62:63], v120 offset0:2 offset1:3
    s_bfe_u32 s91, s90, 0x40009
    s_lshl_b32 s91, s91, 4
    s_or_b32 s91, s91, s90
    v_xor_b32 v69, s91, v84
    s_add_u32 s90, s3, 32
    s_min_u32 s90, s90, 39
    s_lshl_b32 s90, s90, 9
    s_lshr_b32 s91, s90, 9
    s_cmp_lt_u32 s91, 20
    s_cselect_b32 s88, 128, 21
    s_add_u32 s91, s91, s88
    s_lshl_b32 s91, s91, 10
    v_add_u32 v120, s91, v83
    ds_read2st64_b32 v[64:65], v120 offset0:0 offset1:1
    ds_read2st64_b32 v[66:67], v120 offset0:2 offset1:3
    s_bfe_u32 s91, s90, 0x40009
    s_lshl_b32 s91, s91, 4
    s_or_b32 s91, s91, s90
    v_xor_b32 v70, s91, v84
    s_waitcnt lgkmcnt(0)
    s_barrier
    v_cvt_pk_bf16_f32 v56, v56, v57
    v_cvt_pk_bf16_f32 v57, v58, v59
    ds_write_b64 v68, v[56:57]
    v_cvt_pk_bf16_f32 v60, v60, v61
    v_cvt_pk_bf16_f32 v61, v62, v63
    ds_write_b64 v69, v[60:61]
    v_cvt_pk_bf16_f32 v64, v64, v65
    v_cvt_pk_bf16_f32 v65, v66, v67
    ds_write_b64 v70, v[64:65]
    s_waitcnt lgkmcnt(0)
    s_barrier
    ds_read_b128 v[56:59], v2 offset:0
    ds_read_b128 v[60:63], v3 offset:0
    ds_read_b128 v[64:67], v4 offset:0
    ds_read_b128 v[68:71], v5 offset:0
    ds_read_b128 v[72:75], v2 offset:256
    ds_read_b128 v[76:79], v3 offset:256
    ds_read_b128 v[80:83], v4 offset:256
    ds_read_b128 v[84:87], v5 offset:256
    ds_read_b128 v[88:91], v2 offset:8192
    ds_read_b128 v[92:95], v3 offset:8192
    ds_read_b128 v[96:99], v4 offset:8192
    ds_read_b128 v[100:103], v5 offset:8192
    s_branch L_final
L_redo:
    s_waitcnt lgkmcnt(0)
    s_barrier
    s_mov_b32 s79, 1
    v_mov_b64 v[56:57], -1
    s_lshl_b32 s88, s3, 9
    s_add_u32 s88, s88, 41984
    v_lshl_add_u32 v58, v1, 3, s88
    ds_write_b64 v58, v[56:57]
    s_branch L_round
L_enter_x:
    s_cmp_eq_u32 s79, 2
    s_cbranch_scc0 L_loop_x
    s_lshr_b32 s91, s45, 9
    s_cmp_lt_u32 s91, 20
    s_cselect_b32 s88, 128, 21
    s_add_u32 s91, s91, s88
    s_lshl_b32 s91, s91, 10
    v_add_u32 v113, s91, v83
L_loop_x:
    s_and_b32 s88, s28, 3
    s_cbranch_scc1 L_blk_x_0
    s_waitcnt vmcnt(3)
    ds_read_u16_d16_hi v64, v82 offset:1024
    ds_read_u16_d16_hi v65, v82 offset:1152
    ds_read_u16_d16_hi v66, v82 offset:1280
    ds_read_u16_d16_hi v67, v82 offset:1408
    ds_read_u16_d16_hi v68, v82 offset:1536
    ds_read_u16_d16_hi v69, v82 offset:1664
    ds_read_u16_d16_hi v70, v82 offset:1792
    ds_read_u16_d16_hi v71, v82 offset:1920
    ds_read_b64 v[74:75], v117 offset:8
    ds_read_u16 v76, v116 offset:20
    v_pk_fma_f32 v[86:87], v[72:73], v[124:125], v[78:79] op_sel:[0,0,0] op_sel_hi:[0,1,1]
    v_pk_fma_f32 v[88:89], v[72:73], v[126:127], v[80:81] op_sel:[0,0,0] op_sel_hi:[0,1,1]
    v_pk_add_f32 v[90:91], v[56:57], v[86:87]
    v_pk_add_f32 v[92:93], v[58:59], v[88:89]
    v_exp_f32 v94, v90
    v_exp_f32 v95, v91
    v_exp_f32 v96, v92
    v_exp_f32 v97, v93
    v_pk_add_f32 v[94:95], v[94:95], 1.0 op_sel_hi:[1,0]
    v_pk_add_f32 v[96:97], v[96:97], 1.0 op_sel_hi:[1,0]
    v_rcp_f32 v94, v94
    v_rcp_f32 v95, v95
    v_rcp_f32 v96, v96
    v_rcp_f32 v97, v97
    v_pk_fma_f32 v[98:99], v[90:91], v[94:95], v[98:99]
    v_pk_fma_f32 v[100:101], v[92:93], v[96:97], v[100:101]
    v_pk_fma_f32 v[86:87], v[72:73], v[124:125], v[78:79] op_sel:[1,0,0] op_sel_hi:[1,1,1]
    v_pk_fma_f32 v[88:89], v[72:73], v[126:127], v[80:81] op_sel:[1,0,0] op_sel_hi:[1,1,1]
    v_pk_add_f32 v[90:91], v[60:61], v[86:87]
    v_pk_add_f32 v[92:93], v[62:63], v[88:89]
    v_exp_f32 v94, v90
    v_exp_f32 v95, v91
    v_exp_f32 v96, v92
    v_exp_f32 v97, v93
    v_pk_add_f32 v[94:95], v[94:95], 1.0 op_sel_hi:[1,0]
    v_pk_add_f32 v[96:97], v[96:97], 1.0 op_sel_hi:[1,0]
    v_rcp_f32 v94, v94
    v_rcp_f32 v95, v95
    v_rcp_f32 v96, v96
    v_rcp_f32 v97, v97
    v_pk_fma_f32 v[98:99], v[90:91], v[94:95], v[98:99]
    v_pk_fma_f32 v[100:101], v[92:93], v[96:97], v[100:101]
L_back_x_0:
    s_mov_b32 m0, s71
    s_waitcnt lgkmcnt(0)
    buffer_load_dwordx4 v[76:77], s[20:23], 0 idxen offen sc1 lds
    s_and_b32 s88, s28, 12
    s_cbranch_scc1 L_blk_x_1
    s_waitcnt vmcnt(3)
    ds_read_u16_d16_hi v56, v82 offset:32768
    ds_read_u16_d16_hi v57, v82 offset:32896
    ds_read_u16_d16_hi v58, v82 offset:33024
    ds_read_u16_d16_hi v59, v82 offset:33152
    ds_read_u16_d16_hi v60, v82 offset:33280
    ds_read_u16_d16_hi v61, v82 offset:33408
    ds_read_u16_d16_hi v62, v82 offset:33536
    ds_read_u16_d16_hi v63, v82 offset:33664
    ds_read_b64 v[72:73], v117 offset:16
    ds_read_u16 v76, v116 offset:24
    v_pk_fma_f32 v[86:87], v[74:75], v[124:125], v[78:79] op_sel:[0,0,0] op_sel_hi:[0,1,1]
    v_pk_fma_f32 v[88:89], v[74:75], v[126:127], v[80:81] op_sel:[0,0,0] op_sel_hi:[0,1,1]
    v_pk_add_f32 v[90:91], v[64:65], v[86:87]
    v_pk_add_f32 v[92:93], v[66:67], v[88:89]
    v_exp_f32 v94, v90
    v_exp_f32 v95, v91
    v_exp_f32 v96, v92
    v_exp_f32 v97, v93
    v_pk_add_f32 v[94:95], v[94:95], 1.0 op_sel_hi:[1,0]
    v_pk_add_f32 v[96:97], v[96:97], 1.0 op_sel_hi:[1,0]
    v_rcp_f32 v94, v94
    v_rcp_f32 v95, v95
    v_rcp_f32 v96, v96
    v_rcp_f32 v97, v97
    v_pk_fma_f32 v[98:99], v[90:91], v[94:95], v[98:99]
    v_pk_fma_f32 v[100:101], v[92:93], v[96:97], v[100:101]
    v_pk_fma_f32 v[86:87], v[74:75], v[124:125], v[78:79] op_sel:[1,0,0] op_sel_hi:[1,1,1]
    v_pk_fma_f32 v[88:89], v[74:75], v[126:127], v[80:81] op_sel:[1,0,0] op_sel_hi:[1,1,1]
    v_pk_add_f32 v[90:91], v[68:69], v[86:87]
    v_pk_add_f32 v[92:93], v[70:71], v[88:89]
    v_exp_f32 v94, v90
    v_exp_f32 v95, v91
    v_exp_f32 v96, v92
    v_exp_f32 v97, v93
    v_pk_add_f32 v[94:95], v[94:95], 1.0 op_sel_hi:[1,0]
    v_pk_add_f32 v[96:97], v[96:97], 1.0 op_sel_hi:[1,0]
    v_rcp_f32 v94, v94
    v_rcp_f32 v95, v95
    v_rcp_f32 v96, v96
    v_rcp_f32 v97, v97
    v_pk_fma_f32 v[98:99], v[90:91], v[94:95], v[98:99]
    v_pk_fma_f32 v[100:101], v[92:93], v[96:97], v[100:101]
L_back_x_1:
    s_mov_b32 m0, s72
    s_waitcnt lgkmcnt(0)
    buffer_load_dwordx4 v[76:77], s[20:23], 0 idxen offen sc1 lds
    s_and_b32 s88, s28, 48
    s_cbranch_scc1 L_blk_x_2
    s_waitcnt vmcnt(3)
    ds_read_u16_d16_hi v64, v82 offset:33792
    ds_read_u16_d16_hi v65, v82 offset:33920
    ds_read_u16_d16_hi v66, v82 offset:34048
    ds_read_u16_d16_hi v67, v82 offset:34176
    ds_read_u16_d16_hi v68, v82 offset:34304
    ds_read_u16_d16_hi v69, v82 offset:34432
    ds_read_u16_d16_hi v70, v82 offset:34560
    ds_read_u16_d16_hi v71, v82 offset:34688
    ds_read_b64 v[74:75], v117 offset:24
    ds_read_u16 v76, v116 offset:28
    v_pk_fma_f32 v[86:87], v[72:73], v[124:125], v[78:79] op_sel:[0,0,0] op_sel_hi:[0,1,1]
    v_pk_fma_f32 v[88:89], v[72:73], v[126:127], v[80:81] op_sel:[0,0,0] op_sel_hi:[0,1,1]
    v_pk_add_f32 v[90:91], v[56:57], v[86:87]
    v_pk_add_f32 v[92:93], v[58:59], v[88:89]
    v_exp_f32 v94, v90
    v_exp_f32 v95, v91
    v_exp_f32 v96, v92
    v_exp_f32 v97, v93
    v_pk_add_f32 v[94:95], v[94:95], 1.0 op_sel_hi:[1,0]
    v_pk_add_f32 v[96:97], v[96:97], 1.0 op_sel_hi:[1,0]
    v_rcp_f32 v94, v94
    v_rcp_f32 v95, v95
    v_rcp_f32 v96, v96
    v_rcp_f32 v97, v97
    v_pk_fma_f32 v[98:99], v[90:91], v[94:95], v[98:99]
    v_pk_fma_f32 v[100:101], v[92:93], v[96:97], v[100:101]
    v_pk_fma_f32 v[86:87], v[72:73], v[124:125], v[78:79] op_sel:[1,0,0] op_sel_hi:[1,1,1]
    v_pk_fma_f32 v[88:89], v[72:73], v[126:127], v[80:81] op_sel:[1,0,0] op_sel_hi:[1,1,1]
    v_pk_add_f32 v[90:91], v[60:61], v[86:87]
    v_pk_add_f32 v[92:93], v[62:63], v[88:89]
    v_exp_f32 v94, v90
    v_exp_f32 v95, v91
    v_exp_f32 v96, v92
    v_exp_f32 v97, v93
    v_pk_add_f32 v[94:95], v[94:95], 1.0 op_sel_hi:[1,0]
    v_pk_add_f32 v[96:97], v[96:97], 1.0 op_sel_hi:[1,0]
    v_rcp_f32 v94, v94
    v_rcp_f32 v95, v95
    v_rcp_f32 v96, v96
    v_rcp_f32 v97, v97
    v_pk_fma_f32 v[98:99], v[90:91], v[94:95], v[98:99]
    v_pk_fma_f32 v[100:101], v[92:93], v[96:97], v[100:101]
L_back_x_2:
    s_mov_b32 m0, s73
    s_waitcnt lgkmcnt(0)
    buffer_load_dwordx4 v[76:77], s[20:23], 0 idxen offen sc1 lds
    s_and_b32 s88, s28, 192
    s_cbranch_scc1 L_blk_x_3
    s_waitcnt vmcnt(3)
    ds_read_u16_d16_hi v56, v82 offset:0
    ds_read_u16_d16_hi v57, v82 offset:128
    ds_read_u16_d16_hi v58, v82 offset:256
    ds_read_u16_d16_hi v59, v82 offset:384
    ds_read_u16_d16_hi v60, v82 offset:512
    ds_read_u16_d16_hi v61, v82 offset:640
    ds_read_u16_d16_hi v62, v82 offset:768
    ds_read_u16_d16_hi v63, v82 offset:896
    ds_read_b64 v[72:73], v117 offset:32
    ds_read_u16 v76, v116 offset:32
    v_pk_fma_f32 v[86:87], v[74:75], v[124:125], v[78:79] op_sel:[0,0,0] op_sel_hi:[0,1,1]
    v_pk_fma_f32 v[88:89], v[74:75], v[126:127], v[80:81] op_sel:[0,0,0] op_sel_hi:[0,1,1]
    v_pk_add_f32 v[90:91], v[64:65], v[86:87]
    v_pk_add_f32 v[92:93], v[66:67], v[88:89]
    v_exp_f32 v94, v90
    v_exp_f32 v95, v91
    v_exp_f32 v96, v92
    v_exp_f32 v97, v93
    v_pk_add_f32 v[94:95], v[94:95], 1.0 op_sel_hi:[1,0]
    v_pk_add_f32 v[96:97], v[96:97], 1.0 op_sel_hi:[1,0]
    v_rcp_f32 v94, v94
    v_rcp_f32 v95, v95
    v_rcp_f32 v96, v96
    v_rcp_f32 v97, v97
    v_pk_fma_f32 v[98:99], v[90:91], v[94:95], v[98:99]
    v_pk_fma_f32 v[100:101], v[92:93], v[96:97], v[100:101]
    v_pk_fma_f32 v[86:87], v[74:75], v[124:125], v[78:79] op_sel:[1,0,0] op_sel_hi:[1,1,1]
    v_pk_fma_f32 v[88:89], v[74:75], v[126:127], v[80:81] op_sel:[1,0,0] op_sel_hi:[1,1,1]
    v_pk_add_f32 v[90:91], v[68:69], v[86:87]
    v_pk_add_f32 v[92:93], v[70:71], v[88:89]
    v_exp_f32 v94, v90
    v_exp_f32 v95, v91
    v_exp_f32 v96, v92
    v_exp_f32 v97, v93
    v_pk_add_f32 v[94:95], v[94:95], 1.0 op_sel_hi:[1,0]
    v_pk_add_f32 v[96:97], v[96:97], 1.0 op_sel_hi:[1,0]
    v_rcp_f32 v94, v94
    v_rcp_f32 v95, v95
    v_rcp_f32 v96, v96
    v_rcp_f32 v97, v97
    v_pk_fma_f32 v[98:99], v[90:91], v[94:95], v[98:99]
    v_pk_fma_f32 v[100:101], v[92:93], v[96:97], v[100:101]
L_back_x_3:
    s_mov_b32 m0, s70
    s_waitcnt lgkmcnt(0)
    buffer_load_dwordx4 v[76:77], s[20:23], 0 idxen offen sc1 lds
    v_add_u32 v116, 16, v116
    v_add_u32 v117, 32, v117
    s_lshr_b64 s[64:65], s[64:65], 8
    s_or_b32 s65, s65, s69
    s_mov_b32 s69, 0
    s_mov_b32 s28, s64
    s_add_u32 s66, s66, 8
    s_sub_u32 s68, s68, 4
    s_cmp_gt_i32 s68, 12
    s_cbranch_scc1 L_loop_x
    s_cmp_gt_i32 s68, 12
    s_cbranch_scc1 L_nou2_x
    s_cmp_eq_u32 s39, -1
    s_cbranch_scc0 L_nou2_x
    s_lshl_b32 s88, s3, 14
    s_add_u32 s88, s88, 7348224
    s_add_u32 s89, s88, 4096
    v_lshlrev_b32 v120, 4, v1
    buffer_load_dwordx4 v[24:27], v120, s[16:19], s88 offen offset:0 sc1
    buffer_load_dwordx4 v[28:31], v120, s[16:19], s88 offen offset:1024 sc1
    buffer_load_dwordx4 v[32:35], v120, s[16:19], s88 offen offset:2048 sc1
    buffer_load_dwordx4 v[36:39], v120, s[16:19], s88 offen offset:3072 sc1
    buffer_load_dwordx4 v[40:43], v120, s[16:19], s89 offen offset:0 sc1
    buffer_load_dwordx4 v[44:47], v120, s[16:19], s89 offen offset:1024 sc1
    buffer_load_dwordx4 v[48:51], v120, s[16:19], s89 offen offset:2048 sc1
    buffer_load_dwordx4 v[52:55], v120, s[16:19], s89 offen offset:3072 sc1
    s_mov_b32 s39, s66
    s_or_b32 s28, s28, 0xff
L_nou2_x:
    s_branch L_loop_x
L_blk_x_0:
    s_waitcnt vmcnt(11)
    s_cmp_eq_u32 s66, s39
    s_cbranch_scc1 L_blk_x_0_w
    s_waitcnt vmcnt(3)
L_blk_x_0_w:
    ds_read_u16_d16_hi v64, v82 offset:1024
    ds_read_u16_d16_hi v65, v82 offset:1152
    ds_read_u16_d16_hi v66, v82 offset:1280
    ds_read_u16_d16_hi v67, v82 offset:1408
    ds_read_u16_d16_hi v68, v82 offset:1536
    ds_read_u16_d16_hi v69, v82 offset:1664
    ds_read_u16_d16_hi v70, v82 offset:1792
    ds_read_u16_d16_hi v71, v82 offset:1920
    ds_read_b64 v[74:75], v117 offset:8
    ds_read_u16 v76, v116 offset:20
    s_bitcmp1_b32 s64, 0
    s_cbranch_scc1 L_blk_x_0_f0
    v_pk_fma_f32 v[86:87], v[72:73], v[124:125], v[78:79] op_sel:[0,0,0] op_sel_hi:[0,1,1]
    v_pk_fma_f32 v[88:89], v[72:73], v[126:127], v[80:81] op_sel:[0,0,0] op_sel_hi:[0,1,1]
    v_pk_add_f32 v[90:91], v[56:57], v[86:87]
    v_pk_add_f32 v[92:93], v[58:59], v[88:89]
    v_exp_f32 v94, v90
    v_exp_f32 v95, v91
    v_exp_f32 v96, v92
    v_exp_f32 v97, v93
    v_pk_add_f32 v[94:95], v[94:95], 1.0 op_sel_hi:[1,0]
    v_pk_add_f32 v[96:97], v[96:97], 1.0 op_sel_hi:[1,0]
    v_rcp_f32 v94, v94
    v_rcp_f32 v95, v95
    v_rcp_f32 v96, v96
    v_rcp_f32 v97, v97
    v_pk_fma_f32 v[98:99], v[90:91], v[94:95], v[98:99]
    v_pk_fma_f32 v[100:101], v[92:93], v[96:97], v[100:101]
L_blk_x_0_a:
    s_bitcmp1_b32 s64, 1
    s_cbranch_scc1 L_blk_x_0_f1
    v_pk_fma_f32 v[86:87], v[72:73], v[124:125], v[78:79] op_sel:[1,0,0] op_sel_hi:[1,1,1]
    v_pk_fma_f32 v[88:89], v[72:73], v[126:127], v[80:81] op_sel:[1,0,0] op_sel_hi:[1,1,1]
    v_pk_add_f32 v[90:91], v[60:61], v[86:87]
    v_pk_add_f32 v[92:93], v[62:63], v[88:89]
    v_exp_f32 v94, v90
    v_exp_f32 v95, v91
    v_exp_f32 v96, v92
    v_exp_f32 v97, v93
    v_pk_add_f32 v[94:95], v[94:95], 1.0 op_sel_hi:[1,0]
    v_pk_add_f32 v[96:97], v[96:97], 1.0 op_sel_hi:[1,0]
    v_rcp_f32 v94, v94
    v_rcp_f32 v95, v95
    v_rcp_f32 v96, v96
    v_rcp_f32 v97, v97
    v_pk_fma_f32 v[98:99], v[90:91], v[94:95], v[98:99]
    v_pk_fma_f32 v[100:101], v[92:93], v[96:97], v[100:101]
    s_branch L_back_x_0
L_blk_x_0_f0:
    s_add_u32 s88, s66, 0
    s_cmp_eq_u32 s88, s67
    s_cbranch_scc1 L_fin_x
    v_readlane_b32 s89, v118, s88
    s_and_b32 s90, s89, 0xffff
    s_lshr_b32 s91, s89, 16
    v_add_u32 v112, s90, v83
    ds_read2st64_b32 v[78:79], v112 offset0:0 offset1:1
    ds_read2st64_b32 v[80:81], v112 offset0:2 offset1:3
    s_cmp_eq_u32 s79, 2
    s_cbranch_scc1 L_facc_39
    v_cvt_pk_bf16_f32 v94, v98, v99
    v_cvt_pk_bf16_f32 v95, v100, v101
    ds_write_b64 v113, v[94:95]
    v_xor_b32 v113, s91, v84
    s_branch L_fdone_40
L_facc_39:
    ds_add_f32 v113, v98 offset:0
    ds_add_f32 v113, v99 offset:256
    ds_add_f32 v113, v100 offset:512
    ds_add_f32 v113, v101 offset:768
    s_lshr_b32 s91, s91, 9
    s_cmp_lt_u32 s91, 20
    s_cselect_b32 s88, 128, 21
    s_add_u32 s91, s91, s88
    s_lshl_b32 s91, s91, 10
    v_add_u32 v113, s91, v83
L_fdone_40:
    s_waitcnt lgkmcnt(0)
    v_pk_fma_f32 v[86:87], v[72:73], v[124:125], v[78:79] op_sel:[0,0,0] op_sel_hi:[0,1,1]
    v_pk_fma_f32 v[88:89], v[72:73], v[126:127], v[80:81] op_sel:[0,0,0] op_sel_hi:[0,1,1]
    v_pk_add_f32 v[90:91], v[56:57], v[86:87]
    v_pk_add_f32 v[92:93], v[58:59], v[88:89]
    v_exp_f32 v94, v90
    v_exp_f32 v95, v91
    v_exp_f32 v96, v92
    v_exp_f32 v97, v93
    v_pk_add_f32 v[94:95], v[94:95], 1.0 op_sel_hi:[1,0]
    v_pk_add_f32 v[96:97], v[96:97], 1.0 op_sel_hi:[1,0]
    v_rcp_f32 v94, v94
    v_rcp_f32 v95, v95
    v_rcp_f32 v96, v96
    v_rcp_f32 v97, v97
    v_pk_mul_f32 v[98:99], v[90:91], v[94:95]
    v_pk_mul_f32 v[100:101], v[92:93], v[96:97]
    s_branch L_blk_x_0_a
L_blk_x_0_f1:
    s_add_u32 s88, s66, 1
    s_cmp_eq_u32 s88, s67
    s_cbranch_scc1 L_fin_x
    v_readlane_b32 s89, v118, s88
    s_and_b32 s90, s89, 0xffff
    s_lshr_b32 s91, s89, 16
    v_add_u32 v112, s90, v83
    ds_read2st64_b32 v[78:79], v112 offset0:0 offset1:1
    ds_read2st64_b32 v[80:81], v112 offset0:2 offset1:3
    s_cmp_eq_u32 s79, 2
    s_cbranch_scc1 L_facc_41
    v_cvt_pk_bf16_f32 v94, v98, v99
    v_cvt_pk_bf16_f32 v95, v100, v101
    ds_write_b64 v113, v[94:95]
    v_xor_b32 v113, s91, v84
    s_branch L_fdone_42
L_facc_41:
    ds_add_f32 v113, v98 offset:0
    ds_add_f32 v113, v99 offset:256
    ds_add_f32 v113, v100 offset:512
    ds_add_f32 v113, v101 offset:768
    s_lshr_b32 s91, s91, 9
    s_cmp_lt_u32 s91, 20
    s_cselect_b32 s88, 128, 21
    s_add_u32 s91, s91, s88
    s_lshl_b32 s91, s91, 10
    v_add_u32 v113, s91, v83
L_fdone_42:
    s_waitcnt lgkmcnt(0)
    v_pk_fma_f32 v[86:87], v[72:73], v[124:125], v[78:79] op_sel:[1,0,0] op_sel_hi:[1,1,1]
    v_pk_fma_f32 v[88:89], v[72:73], v[126:127], v[80:81] op_sel:[1,0,0] op_sel_hi:[1,1,1]
    v_pk_add_f32 v[90:91], v[60:61], v[86:87]
    v_pk_add_f32 v[92:93], v[62:63], v[88:89]
    v_exp_f32 v94, v90
    v_exp_f32 v95, v91
    v_exp_f32 v96, v92
    v_exp_f32 v97, v93
    v_pk_add_f32 v[94:95], v[94:95], 1.0 op_sel_hi:[1,0]
    v_pk_add_f32 v[96:97], v[96:97], 1.0 op_sel_hi:[1,0]
    v_rcp_f32 v94, v94
    v_rcp_f32 v95, v95
    v_rcp_f32 v96, v96
    v_rcp_f32 v97, v97
    v_pk_mul_f32 v[98:99], v[90:91], v[94:95]
    v_pk_mul_f32 v[100:101], v[92:93], v[96:97]
    s_branch L_back_x_0
L_blk_x_1:
    s_waitcnt vmcnt(11)
    s_cmp_eq_u32 s66, s39
    s_cbranch_scc1 L_blk_x_1_w
    s_waitcnt vmcnt(3)
L_blk_x_1_w:
    ds_read_u16_d16_hi v56, v82 offset:32768
    ds_read_u16_d16_hi v57, v82 offset:32896
    ds_read_u16_d16_hi v58, v82 offset:33024
    ds_read_u16_d16_hi v59, v82 offset:33152
    ds_read_u16_d16_hi v60, v82 offset:33280
    ds_read_u16_d16_hi v61, v82 offset:33408
    ds_read_u16_d16_hi v62, v82 offset:33536
    ds_read_u16_d16_hi v63, v82 offset:33664
    ds_read_b64 v[72:73], v117 offset:16
    ds_read_u16 v76, v116 offset:24
    s_bitcmp1_b32 s64, 2
    s_cbranch_scc1 L_blk_x_1_f0
    v_pk_fma_f32 v[86:87], v[74:75], v[124:125], v[78:79] op_sel:[0,0,0] op_sel_hi:[0,1,1]
    v_pk_fma_f32 v[88:89], v[74:75], v[126:127], v[80:81] op_sel:[0,0,0] op_sel_hi:[0,1,1]
    v_pk_add_f32 v[90:91], v[64:65], v[86:87]
    v_pk_add_f32 v[92:93], v[66:67], v[88:89]
    v_exp_f32 v94, v90
    v_exp_f32 v95, v91
    v_exp_f32 v96, v92
    v_exp_f32 v97, v93
    v_pk_add_f32 v[94:95], v[94:95], 1.0 op_sel_hi:[1,0]
    v_pk_add_f32 v[96:97], v[96:97], 1.0 op_sel_hi:[1,0]
    v_rcp_f32 v94, v94
    v_rcp_f32 v95, v95
    v_rcp_f32 v96, v96
    v_rcp_f32 v97, v97
    v_pk_fma_f32 v[98:99], v[90:91], v[94:95], v[98:99]
    v_pk_fma_f32 v[100:101], v[92:93], v[96:97], v[100:101]
L_blk_x_1_a:
    s_bitcmp1_b32 s64, 3
    s_cbranch_scc1 L_blk_x_1_f1
    v_pk_fma_f32 v[86:87], v[74:75], v[124:125], v[78:79] op_sel:[1,0,0] op_sel_hi:[1,1,1]
    v_pk_fma_f32 v[88:89], v[74:75], v[126:127], v[80:81] op_sel:[1,0,0] op_sel_hi:[1,1,1]
    v_pk_add_f32 v[90:91], v[68:69], v[86:87]
    v_pk_add_f32 v[92:93], v[70:71], v[88:89]
    v_exp_f32 v94, v90
    v_exp_f32 v95, v91
    v_exp_f32 v96, v92
    v_exp_f32 v97, v93
    v_pk_add_f32 v[94:95], v[94:95], 1.0 op_sel_hi:[1,0]
    v_pk_add_f32 v[96:97], v[96:97], 1.0 op_sel_hi:[1,0]
    v_rcp_f32 v94, v94
    v_rcp_f32 v95, v95
    v_rcp_f32 v96, v96
    v_rcp_f32 v97, v97
    v_pk_fma_f32 v[98:99], v[90:91], v[94:95], v[98:99]
    v_pk_fma_f32 v[100:101], v[92:93], v[96:97], v[100:101]
    s_branch L_back_x_1
L_blk_x_1_f0:
    s_add_u32 s88, s66, 2
    s_cmp_eq_u32 s88, s67
    s_cbranch_scc1 L_fin_x
    v_readlane_b32 s89, v118, s88
    s_and_b32 s90, s89, 0xffff
    s_lshr_b32 s91, s89, 16
    v_add_u32 v112, s90, v83
    ds_read2st64_b32 v[78:79], v112 offset0:0 offset1:1
    ds_read2st64_b32 v[80:81], v112 offset0:2 offset1:3
    s_cmp_eq_u32 s79, 2
    s_cbranch_scc1 L_facc_43
    v_cvt_pk_bf16_f32 v94, v98, v99
    v_cvt_pk_bf16_f32 v95, v100, v101
    ds_write_b64 v113, v[94:95]
    v_xor_b32 v113, s91, v84
    s_branch L_fdone_44
L_facc_43:
    ds_add_f32 v113, v98 offset:0
    ds_add_f32 v113, v99 offset:256
    ds_add_f32 v113, v100 offset:512
    ds_add_f32 v113, v101 offset:768
    s_lshr_b32 s91, s91, 9
    s_cmp_lt_u32 s91, 20
    s_cselect_b32 s88, 128, 21
    s_add_u32 s91, s91, s88
    s_lshl_b32 s91, s91, 10
    v_add_u32 v113, s91, v83
L_fdone_44:
    s_waitcnt lgkmcnt(0)
    v_pk_fma_f32 v[86:87], v[74:75], v[124:125], v[78:79] op_sel:[0,0,0] op_sel_hi:[0,1,1]
    v_pk_fma_f32 v[88:89], v[74:75], v[126:127], v[80:81] op_sel:[0,0,0] op_sel_hi:[0,1,1]
    v_pk_add_f32 v[90:91], v[64:65], v[86:87]
    v_pk_add_f32 v[92:93], v[66:67], v[88:89]
    v_exp_f32 v94, v90
    v_exp_f32 v95, v91
    v_exp_f32 v96, v92
    v_exp_f32 v97, v93
    v_pk_add_f32 v[94:95], v[94:95], 1.0 op_sel_hi:[1,0]
    v_pk_add_f32 v[96:97], v[96:97], 1.0 op_sel_hi:[1,0]
    v_rcp_f32 v94, v94
    v_rcp_f32 v95, v95
    v_rcp_f32 v96, v96
    v_rcp_f32 v97, v97
    v_pk_mul_f32 v[98:99], v[90:91], v[94:95]
    v_pk_mul_f32 v[100:101], v[92:93], v[96:97]
    s_branch L_blk_x_1_a
L_blk_x_1_f1:
    s_add_u32 s88, s66, 3
    s_cmp_eq_u32 s88, s67
    s_cbranch_scc1 L_fin_x
    v_readlane_b32 s89, v118, s88
    s_and_b32 s90, s89, 0xffff
    s_lshr_b32 s91, s89, 16
    v_add_u32 v112, s90, v83
    ds_read2st64_b32 v[78:79], v112 offset0:0 offset1:1
    ds_read2st64_b32 v[80:81], v112 offset0:2 offset1:3
    s_cmp_eq_u32 s79, 2
    s_cbranch_scc1 L_facc_45
    v_cvt_pk_bf16_f32 v94, v98, v99
    v_cvt_pk_bf16_f32 v95, v100, v101
    ds_write_b64 v113, v[94:95]
    v_xor_b32 v113, s91, v84
    s_branch L_fdone_46
L_facc_45:
    ds_add_f32 v113, v98 offset:0
    ds_add_f32 v113, v99 offset:256
    ds_add_f32 v113, v100 offset:512
    ds_add_f32 v113, v101 offset:768
    s_lshr_b32 s91, s91, 9
    s_cmp_lt_u32 s91, 20
    s_cselect_b32 s88, 128, 21
    s_add_u32 s91, s91, s88
    s_lshl_b32 s91, s91, 10
    v_add_u32 v113, s91, v83
L_fdone_46:
    s_waitcnt lgkmcnt(0)
    v_pk_fma_f32 v[86:87], v[74:75], v[124:125], v[78:79] op_sel:[1,0,0] op_sel_hi:[1,1,1]
    v_pk_fma_f32 v[88:89], v[74:75], v[126:127], v[80:81] op_sel:[1,0,0] op_sel_hi:[1,1,1]
    v_pk_add_f32 v[90:91], v[68:69], v[86:87]
    v_pk_add_f32 v[92:93], v[70:71], v[88:89]
    v_exp_f32 v94, v90
    v_exp_f32 v95, v91
    v_exp_f32 v96, v92
    v_exp_f32 v97, v93
    v_pk_add_f32 v[94:95], v[94:95], 1.0 op_sel_hi:[1,0]
    v_pk_add_f32 v[96:97], v[96:97], 1.0 op_sel_hi:[1,0]
    v_rcp_f32 v94, v94
    v_rcp_f32 v95, v95
    v_rcp_f32 v96, v96
    v_rcp_f32 v97, v97
    v_pk_mul_f32 v[98:99], v[90:91], v[94:95]
    v_pk_mul_f32 v[100:101], v[92:93], v[96:97]
    s_branch L_back_x_1
L_blk_x_2:
    s_waitcnt vmcnt(11)
    s_cmp_eq_u32 s66, s39
    s_cbranch_scc1 L_blk_x_2_w
    s_waitcnt vmcnt(3)
L_blk_x_2_w:
    ds_read_u16_d16_hi v64, v82 offset:33792
    ds_read_u16_d16_hi v65, v82 offset:33920
    ds_read_u16_d16_hi v66, v82 offset:34048
    ds_read_u16_d16_hi v67, v82 offset:34176
    ds_read_u16_d16_hi v68, v82 offset:34304
    ds_read_u16_d16_hi v69, v82 offset:34432
    ds_read_u16_d16_hi v70, v82 offset:34560
    ds_read_u16_d16_hi v71, v82 offset:34688
    ds_read_b64 v[74:75], v117 offset:24
    ds_read_u16 v76, v116 offset:28
    s_bitcmp1_b32 s64, 4
    s_cbranch_scc1 L_blk_x_2_f0
    v_pk_fma_f32 v[86:87], v[72:73], v[124:125], v[78:79] op_sel:[0,0,0] op_sel_hi:[0,1,1]
    v_pk_fma_f32 v[88:89], v[72:73], v[126:127], v[80:81] op_sel:[0,0,0] op_sel_hi:[0,1,1]
    v_pk_add_f32 v[90:91], v[56:57], v[86:87]
    v_pk_add_f32 v[92:93], v[58:59], v[88:89]
    v_exp_f32 v94, v90
    v_exp_f32 v95, v91
    v_exp_f32 v96, v92
    v_exp_f32 v97, v93
    v_pk_add_f32 v[94:95], v[94:95], 1.0 op_sel_hi:[1,0]
    v_pk_add_f32 v[96:97], v[96:97], 1.0 op_sel_hi:[1,0]
    v_rcp_f32 v94, v94
    v_rcp_f32 v95, v95
    v_rcp_f32 v96, v96
    v_rcp_f32 v97, v97
    v_pk_fma_f32 v[98:99], v[90:91], v[94:95], v[98:99]
    v_pk_fma_f32 v[100:101], v[92:93], v[96:97], v[100:101]
L_blk_x_2_a:
    s_bitcmp1_b32 s64, 5
    s_cbranch_scc1 L_blk_x_2_f1
    v_pk_fma_f32 v[86:87], v[72:73], v[124:125], v[78:79] op_sel:[1,0,0] op_sel_hi:[1,1,1]
    v_pk_fma_f32 v[88:89], v[72:73], v[126:127], v[80:81] op_sel:[1,0,0] op_sel_hi:[1,1,1]
    v_pk_add_f32 v[90:91], v[60:61], v[86:87]
    v_pk_add_f32 v[92:93], v[62:63], v[88:89]
    v_exp_f32 v94, v90
    v_exp_f32 v95, v91
    v_exp_f32 v96, v92
    v_exp_f32 v97, v93
    v_pk_add_f32 v[94:95], v[94:95], 1.0 op_sel_hi:[1,0]
    v_pk_add_f32 v[96:97], v[96:97], 1.0 op_sel_hi:[1,0]
    v_rcp_f32 v94, v94
    v_rcp_f32 v95, v95
    v_rcp_f32 v96, v96
    v_rcp_f32 v97, v97
    v_pk_fma_f32 v[98:99], v[90:91], v[94:95], v[98:99]
    v_pk_fma_f32 v[100:101], v[92:93], v[96:97], v[100:101]
    s_branch L_back_x_2
L_blk_x_2_f0:
    s_add_u32 s88, s66, 4
    s_cmp_eq_u32 s88, s67
    s_cbranch_scc1 L_fin_x
    v_readlane_b32 s89, v118, s88
    s_and_b32 s90, s89, 0xffff
    s_lshr_b32 s91, s89, 16
    v_add_u32 v112, s90, v83
    ds_read2st64_b32 v[78:79], v112 offset0:0 offset1:1
    ds_read2st64_b32 v[80:81], v112 offset0:2 offset1:3
    s_cmp_eq_u32 s79, 2
    s_cbranch_scc1 L_facc_47
    v_cvt_pk_bf16_f32 v94, v98, v99
    v_cvt_pk_bf16_f32 v95, v100, v101
    ds_write_b64 v113, v[94:95]
    v_xor_b32 v113, s91, v84
    s_branch L_fdone_48
L_facc_47:
    ds_add_f32 v113, v98 offset:0
    ds_add_f32 v113, v99 offset:256
    ds_add_f32 v113, v100 offset:512
    ds_add_f32 v113, v101 offset:768
    s_lshr_b32 s91, s91, 9
    s_cmp_lt_u32 s91, 20
    s_cselect_b32 s88, 128, 21
    s_add_u32 s91, s91, s88
    s_lshl_b32 s91, s91, 10
    v_add_u32 v113, s91, v83
L_fdone_48:
    s_waitcnt lgkmcnt(0)
    v_pk_fma_f32 v[86:87], v[72:73], v[124:125], v[78:79] op_sel:[0,0,0] op_sel_hi:[0,1,1]
    v_pk_fma_f32 v[88:89], v[72:73], v[126:127], v[80:81] op_sel:[0,0,0] op_sel_hi:[0,1,1]
    v_pk_add_f32 v[90:91], v[56:57], v[86:87]
    v_pk_add_f32 v[92:93], v[58:59], v[88:89]
    v_exp_f32 v94, v90
    v_exp_f32 v95, v91
    v_exp_f32 v96, v92
    v_exp_f32 v97, v93
    v_pk_add_f32 v[94:95], v[94:95], 1.0 op_sel_hi:[1,0]
    v_pk_add_f32 v[96:97], v[96:97], 1.0 op_sel_hi:[1,0]
    v_rcp_f32 v94, v94
    v_rcp_f32 v95, v95
    v_rcp_f32 v96, v96
    v_rcp_f32 v97, v97
    v_pk_mul_f32 v[98:99], v[90:91], v[94:95]
    v_pk_mul_f32 v[100:101], v[92:93], v[96:97]
    s_branch L_blk_x_2_a
L_blk_x_2_f1:
    s_add_u32 s88, s66, 5
    s_cmp_eq_u32 s88, s67
    s_cbranch_scc1 L_fin_x
    v_readlane_b32 s89, v118, s88
    s_and_b32 s90, s89, 0xffff
    s_lshr_b32 s91, s89, 16
    v_add_u32 v112, s90, v83
    ds_read2st64_b32 v[78:79], v112 offset0:0 offset1:1
    ds_read2st64_b32 v[80:81], v112 offset0:2 offset1:3
    s_cmp_eq_u32 s79, 2
    s_cbranch_scc1 L_facc_49
    v_cvt_pk_bf16_f32 v94, v98, v99
    v_cvt_pk_bf16_f32 v95, v100, v101
    ds_write_b64 v113, v[94:95]
    v_xor_b32 v113, s91, v84
    s_branch L_fdone_50
L_facc_49:
    ds_add_f32 v113, v98 offset:0
    ds_add_f32 v113, v99 offset:256
    ds_add_f32 v113, v100 offset:512
    ds_add_f32 v113, v101 offset:768
    s_lshr_b32 s91, s91, 9
    s_cmp_lt_u32 s91, 20
    s_cselect_b32 s88, 128, 21
    s_add_u32 s91, s91, s88
    s_lshl_b32 s91, s91, 10
    v_add_u32 v113, s91, v83
L_fdone_50:
    s_waitcnt lgkmcnt(0)
    v_pk_fma_f32 v[86:87], v[72:73], v[124:125], v[78:79] op_sel:[1,0,0] op_sel_hi:[1,1,1]
    v_pk_fma_f32 v[88:89], v[72:73], v[126:127], v[80:81] op_sel:[1,0,0] op_sel_hi:[1,1,1]
    v_pk_add_f32 v[90:91], v[60:61], v[86:87]
    v_pk_add_f32 v[92:93], v[62:63], v[88:89]
    v_exp_f32 v94, v90
    v_exp_f32 v95, v91
    v_exp_f32 v96, v92
    v_exp_f32 v97, v93
    v_pk_add_f32 v[94:95], v[94:95], 1.0 op_sel_hi:[1,0]
    v_pk_add_f32 v[96:97], v[96:97], 1.0 op_sel_hi:[1,0]
    v_rcp_f32 v94, v94
    v_rcp_f32 v95, v95
    v_rcp_f32 v96, v96
    v_rcp_f32 v97, v97
    v_pk_mul_f32 v[98:99], v[90:91], v[94:95]
    v_pk_mul_f32 v[100:101], v[92:93], v[96:97]
    s_branch L_back_x_2
L_blk_x_3:
    s_waitcnt vmcnt(11)
    s_cmp_eq_u32 s66, s39
    s_cbranch_scc1 L_blk_x_3_w
    s_waitcnt vmcnt(3)
L_blk_x_3_w:
    ds_read_u16_d16_hi v56, v82 offset:0
    ds_read_u16_d16_hi v57, v82 offset:128
    ds_read_u16_d16_hi v58, v82 offset:256
    ds_read_u16_d16_hi v59, v82 offset:384
    ds_read_u16_d16_hi v60, v82 offset:512
    ds_read_u16_d16_hi v61, v82 offset:640
    ds_read_u16_d16_hi v62, v82 offset:768
    ds_read_u16_d16_hi v63, v82 offset:896
    ds_read_b64 v[72:73], v117 offset:32
    ds_read_u16 v76, v116 offset:32
    s_bitcmp1_b32 s64, 6
    s_cbranch_scc1 L_blk_x_3_f0
    v_pk_fma_f32 v[86:87], v[74:75], v[124:125], v[78:79] op_sel:[0,0,0] op_sel_hi:[0,1,1]
    v_pk_fma_f32 v[88:89], v[74:75], v[126:127], v[80:81] op_sel:[0,0,0] op_sel_hi:[0,1,1]
    v_pk_add_f32 v[90:91], v[64:65], v[86:87]
    v_pk_add_f32 v[92:93], v[66:67], v[88:89]
    v_exp_f32 v94, v90
    v_exp_f32 v95, v91
    v_exp_f32 v96, v92
    v_exp_f32 v97, v93
    v_pk_add_f32 v[94:95], v[94:95], 1.0 op_sel_hi:[1,0]
    v_pk_add_f32 v[96:97], v[96:97], 1.0 op_sel_hi:[1,0]
    v_rcp_f32 v94, v94
    v_rcp_f32 v95, v95
    v_rcp_f32 v96, v96
    v_rcp_f32 v97, v97
    v_pk_fma_f32 v[98:99], v[90:91], v[94:95], v[98:99]
    v_pk_fma_f32 v[100:101], v[92:93], v[96:97], v[100:101]
L_blk_x_3_a:
    s_bitcmp1_b32 s64, 7
    s_cbranch_scc1 L_blk_x_3_f1
    v_pk_fma_f32 v[86:87], v[74:75], v[124:125], v[78:79] op_sel:[1,0,0] op_sel_hi:[1,1,1]
    v_pk_fma_f32 v[88:89], v[74:75], v[126:127], v[80:81] op_sel:[1,0,0] op_sel_hi:[1,1,1]
    v_pk_add_f32 v[90:91], v[68:69], v[86:87]
    v_pk_add_f32 v[92:93], v[70:71], v[88:89]
    v_exp_f32 v94, v90
    v_exp_f32 v95, v91
    v_exp_f32 v96, v92
    v_exp_f32 v97, v93
    v_pk_add_f32 v[94:95], v[94:95], 1.0 op_sel_hi:[1,0]
    v_pk_add_f32 v[96:97], v[96:97], 1.0 op_sel_hi:[1,0]
    v_rcp_f32 v94, v94
    v_rcp_f32 v95, v95
    v_rcp_f32 v96, v96
    v_rcp_f32 v97, v97
    v_pk_fma_f32 v[98:99], v[90:91], v[94:95], v[98:99]
    v_pk_fma_f32 v[100:101], v[92:93], v[96:97], v[100:101]
    s_branch L_back_x_3
L_blk_x_3_f0:
    s_add_u32 s88, s66, 6
    s_cmp_eq_u32 s88, s67
    s_cbranch_scc1 L_fin_x
    v_readlane_b32 s89, v118, s88
    s_and_b32 s90, s89, 0xffff
    s_lshr_b32 s91, s89, 16
    v_add_u32 v112, s90, v83
    ds_read2st64_b32 v[78:79], v112 offset0:0 offset1:1
    ds_read2st64_b32 v[80:81], v112 offset0:2 offset1:3
    s_cmp_eq_u32 s79, 2
    s_cbranch_scc1 L_facc_51
    v_cvt_pk_bf16_f32 v94, v98, v99
    v_cvt_pk_bf16_f32 v95, v100, v101
    ds_write_b64 v113, v[94:95]
    v_xor_b32 v113, s91, v84
    s_branch L_fdone_52
L_facc_51:
    ds_add_f32 v113, v98 offset:0
    ds_add_f32 v113, v99 offset:256
    ds_add_f32 v113, v100 offset:512
    ds_add_f32 v113, v101 offset:768
    s_lshr_b32 s91, s91, 9
    s_cmp_lt_u32 s91, 20
    s_cselect_b32 s88, 128, 21
    s_add_u32 s91, s91, s88
    s_lshl_b32 s91, s91, 10
    v_add_u32 v113, s91, v83
L_fdone_52:
    s_waitcnt lgkmcnt(0)
    v_pk_fma_f32 v[86:87], v[74:75], v[124:125], v[78:79] op_sel:[0,0,0] op_sel_hi:[0,1,1]
    v_pk_fma_f32 v[88:89], v[74:75], v[126:127], v[80:81] op_sel:[0,0,0] op_sel_hi:[0,1,1]
    v_pk_add_f32 v[90:91], v[64:65], v[86:87]
    v_pk_add_f32 v[92:93], v[66:67], v[88:89]
    v_exp_f32 v94, v90
    v_exp_f32 v95, v91
    v_exp_f32 v96, v92
    v_exp_f32 v97, v93
    v_pk_add_f32 v[94:95], v[94:95], 1.0 op_sel_hi:[1,0]
    v_pk_add_f32 v[96:97], v[96:97], 1.0 op_sel_hi:[1,0]
    v_rcp_f32 v94, v94
    v_rcp_f32 v95, v95
    v_rcp_f32 v96, v96
    v_rcp_f32 v97, v97
    v_pk_mul_f32 v[98:99], v[90:91], v[94:95]
    v_pk_mul_f32 v[100:101], v[92:93], v[96:97]
    s_branch L_blk_x_3_a
L_blk_x_3_f1:
    s_add_u32 s88, s66, 7
    s_cmp_eq_u32 s88, s67
    s_cbranch_scc1 L_fin_x
    v_readlane_b32 s89, v118, s88
    s_and_b32 s90, s89, 0xffff
    s_lshr_b32 s91, s89, 16
    v_add_u32 v112, s90, v83
    ds_read2st64_b32 v[78:79], v112 offset0:0 offset1:1
    ds_read2st64_b32 v[80:81], v112 offset0:2 offset1:3
    s_cmp_eq_u32 s79, 2
    s_cbranch_scc1 L_facc_53
    v_cvt_pk_bf16_f32 v94, v98, v99
    v_cvt_pk_bf16_f32 v95, v100, v101
    ds_write_b64 v113, v[94:95]
    v_xor_b32 v113, s91, v84
    s_branch L_fdone_54
L_facc_53:
    ds_add_f32 v113, v98 offset:0
    ds_add_f32 v113, v99 offset:256
    ds_add_f32 v113, v100 offset:512
    ds_add_f32 v113, v101 offset:768
    s_lshr_b32 s91, s91, 9
    s_cmp_lt_u32 s91, 20
    s_cselect_b32 s88, 128, 21
    s_add_u32 s91, s91, s88
    s_lshl_b32 s91, s91, 10
    v_add_u32 v113, s91, v83
L_fdone_54:
    s_waitcnt lgkmcnt(0)
    v_pk_fma_f32 v[86:87], v[74:75], v[124:125], v[78:79] op_sel:[1,0,0] op_sel_hi:[1,1,1]
    v_pk_fma_f32 v[88:89], v[74:75], v[126:127], v[80:81] op_sel:[1,0,0] op_sel_hi:[1,1,1]
    v_pk_add_f32 v[90:91], v[68:69], v[86:87]
    v_pk_add_f32 v[92:93], v[70:71], v[88:89]
    v_exp_f32 v94, v90
    v_exp_f32 v95, v91
    v_exp_f32 v96, v92
    v_exp_f32 v97, v93
    v_pk_add_f32 v[94:95], v[94:95], 1.0 op_sel_hi:[1,0]
    v_pk_add_f32 v[96:97], v[96:97], 1.0 op_sel_hi:[1,0]
    v_rcp_f32 v94, v94
    v_rcp_f32 v95, v95
    v_rcp_f32 v96, v96
    v_rcp_f32 v97, v97
    v_pk_mul_f32 v[98:99], v[90:91], v[94:95]
    v_pk_mul_f32 v[100:101], v[92:93], v[96:97]
    s_branch L_back_x_3
L_fin_x:
    s_cmp_eq_u32 s79, 2
    s_cbranch_scc1 L_facc_55
    s_cmp_eq_u32 s48, 0
    s_cbranch_scc1 L_noside_x
    s_lshl_b32 s88, s3, 9
    s_add_u32 s88, s88, 173568
    v_xor_b32 v112, s88, v84
    s_mov_b32 s90, 0
L_side_x:
    ds_read_b64 v[94:95], v112
    s_add_u32 s90, s90, 1
    s_waitcnt lgkmcnt(0)
    v_cmp_eq_u64 vcc, -1, v[94:95]
    s_cmp_gt_u32 s90, 40000
    s_cbranch_scc1 L_side_go_x
    s_cbranch_vccnz L_side_x
L_side_go_x:
    v_lshlrev_b32 v86, 16, v94
    v_and_b32 v87, 0xffff0000, v94
    v_lshlrev_b32 v88, 16, v95
    v_and_b32 v89, 0xffff0000, v95
    v_pk_add_f32 v[98:99], v[98:99], v[86:87]
    v_pk_add_f32 v[100:101], v[100:101], v[88:89]
L_noside_x:
    v_cvt_pk_bf16_f32 v94, v98, v99
    v_cvt_pk_bf16_f32 v95, v100, v101
    ds_write_b64 v113, v[94:95]
    v_xor_b32 v113, s91, v84
    s_branch L_fdone_56
L_facc_55:
    ds_add_f32 v113, v98 offset:0
    ds_add_f32 v113, v99 offset:256
    ds_add_f32 v113, v100 offset:512
    ds_add_f32 v113, v101 offset:768
L_fdone_56:
    s_waitcnt lgkmcnt(0)
    s_cmp_eq_u32 s39, -1
    s_cbranch_scc0 L_after
    s_lshl_b32 s88, s3, 14
    s_add_u32 s88, s88, 7348224
    s_add_u32 s89, s88, 4096
    v_lshlrev_b32 v120, 4, v1
    buffer_load_dwordx4 v[24:27], v120, s[16:19], s88 offen offset:0 sc1
    buffer_load_dwordx4 v[28:31], v120, s[16:19], s88 offen offset:1024 sc1
    buffer_load_dwordx4 v[32:35], v120, s[16:19], s88 offen offset:2048 sc1
    buffer_load_dwordx4 v[36:39], v120, s[16:19], s88 offen offset:3072 sc1
    buffer_load_dwordx4 v[40:43], v120, s[16:19], s89 offen offset:0 sc1
    buffer_load_dwordx4 v[44:47], v120, s[16:19], s89 offen offset:1024 sc1
    buffer_load_dwordx4 v[48:51], v120, s[16:19], s89 offen offset:2048 sc1
    buffer_load_dwordx4 v[52:55], v120, s[16:19], s89 offen offset:3072 sc1
    s_branch L_after
L_code_end:
.section .rodata,"a"
.p2align 6
.amdhsa_kernel gather_scatter__mpnn_edge_mlp__graph_kernel
  .amdhsa_next_free_vgpr 128
  .amdhsa_next_free_sgpr 92
  .amdhsa_accum_offset 128
  .amdhsa_group_segment_fixed_size 0
  .amdhsa_kernarg_size 72
  .amdhsa_user_sgpr_count 2
  .amdhsa_user_sgpr_kernarg_segment_ptr 1
  .amdhsa_system_sgpr_workgroup_id_x 1
.end_amdhsa_kernel
```
